```python
import torch

def _softmax(x, axis=-1):
    return torch.softmax(x, dim=axis)
def _gelu(x):
    return torch.nn.functional.gelu(x, approximate="tanh")
def _silu(x):
    return torch.nn.functional.silu(x)
def _sigmoid(x):
    return torch.sigmoid(x)
def _layernorm(x, axis=-1, eps=1e-5):
    m = x.mean(dim=axis, keepdim=True)
    v = x.var(dim=axis, keepdim=True, unbiased=False)
    return (x - m) / torch.sqrt(v + eps)
def _scatter_add(tgt, idx, src, axis=0):
    return tgt.clone().index_add_(axis, idx, src)
def _segment_sum(src, seg, n):
    out = torch.zeros((n,) + src.shape[1:], dtype=src.dtype)
    return out.index_add_(0, seg, src)
def _pad(x, pw):
    flat = tuple(v for pair in reversed(pw) for v in pair)
    return torch.nn.functional.pad(x, flat)

kernel_name = 'gated_mix__ssm_conv_h3__grouped_kv_mqa__prompt'

def setup_inputs():

    _w = (lambda a: (lambda t: t.to(torch.bfloat16) if t.is_floating_point() else t)(torch.as_tensor(a)))
    def _A_setup():
        B, S, D = 1, 2048, 1024
        ks = 4
        return {
            "q": _w((lambda *s: torch.randn(*s, dtype=torch.bfloat16) * 0.05)(B, S, D)),
            "k": _w((lambda *s: torch.randn(*s, dtype=torch.bfloat16) * 0.4)(B, S, D)),
            "v": _w((lambda *s: torch.randn(*s, dtype=torch.bfloat16) * 0.4)(B, S, D)),
            "shift_k": _w((lambda *s: torch.randn(*s, dtype=torch.bfloat16) * 0.4)(D, ks) * 0.5),
            "ssm_k": _w((lambda *s: torch.randn(*s, dtype=torch.bfloat16) * 0.8)(D, S) * (1.0 / S ** 0.5)),
            "ssm_D": _w((lambda *s: torch.randn(*s, dtype=torch.bfloat16) * 0.4)(D)),
        }
    _A_in = _A_setup()

    def _B_setup():
        B, S, D, H = 1, 2048, 1024, 32
        Dh = D // H
        return {
            "x": _w((lambda *s: torch.randn(*s, dtype=torch.bfloat16) * 0.05)(B, S, D)),
            "wq": _w((lambda *s: torch.randn(*s, dtype=torch.bfloat16) * 0.8)(D, H * Dh)),
            "wk": _w((lambda *s: torch.randn(*s, dtype=torch.bfloat16) * 0.8)(D, Dh)),
            "wv": _w((lambda *s: torch.randn(*s, dtype=torch.bfloat16) * 0.05)(D, Dh)),
            "wo": _w((lambda *s: torch.randn(*s, dtype=torch.bfloat16) * 0.05)(H * Dh, D)),
        }
    _B_in = _B_setup()

    return {
        "A_q": _A_in["q"],
        "A_k": _A_in["k"],
        "A_v": _A_in["v"],
        "A_shift_k": _A_in["shift_k"],
        "A_ssm_k": _A_in["ssm_k"],
        "A_ssm_D": _A_in["ssm_D"],
        "B_x": _B_in["x"],
        "B_wq": _B_in["wq"],
        "B_wk": _B_in["wk"],
        "B_wv": _B_in["wv"],
        "B_wo": _B_in["wo"],
        "gate_w": _w((lambda *s: torch.randn(*s, dtype=torch.bfloat16) * 0.05)(1024) * 16.0),
    }

def reference(A_q, A_k, A_v, A_shift_k, A_ssm_k, A_ssm_D, B_x, B_wq, B_wk, B_wv, B_wo, gate_w):
    def _A_ref(q, k, v, shift_k, ssm_k, ssm_D):
        B, S, D = q.shape
        ks = shift_k.shape[-1]
        k_pad = _pad(k, ((0, 0), (ks - 1, 0), (0, 0)))
        k_shift = torch.zeros_like(k)
        for t in range(ks):
            k_shift = k_shift + k_pad[:, t:t + S, :] * shift_k[:, ks - 1 - t][None, None, :]
        kv = k_shift * v
        L = 2 * S
        kv_pad = _pad(kv, ((0, 0), (0, S), (0, 0)))
        kf_pad = _pad(ssm_k, ((0, 0), (0, S)))
        kv_f = (lambda x, axes=(-2,-1): torch.fft.rfft2(x.float(), dim=axes))(kv_pad[:, None, :, :], axes=(1, 2))
        kf_f = (lambda x, axes=(-2,-1): torch.fft.rfft2(x.float(), dim=axes))(kf_pad[:, None, :], axes=(1, 2))
        kf_f = (lambda x, *d: x.permute(*d))(kf_f, 1, 2, 0)
        y_f = kv_f * kf_f[None, :, :, :]
        y = (lambda x, s, axes=(-2,-1): torch.fft.irfft2(x, s=s, dim=axes).to(torch.bfloat16))(y_f, (1, L), axes=(1, 2))[:, 0, :S, :]
        y = y + kv * ssm_D[None, None, :]
        return q * y

    def _B_ref(x, wq, wk, wv, wo):
        B, S, D = x.shape
        H = 32
        Dh = D // H
        q = (lambda x, *d: x.permute(*d))((x @ wq).reshape(B, S, H, Dh), 0, 2, 1, 3)
        k = x @ wk
        v = x @ wv
        scores = torch.einsum("bhqd,bkd->bhqk", q, k) * (Dh ** -0.5)
        p = _softmax(scores, axis=-1)
        o = torch.einsum("bhqk,bkd->bhqd", p, v)
        return (lambda x, *d: x.permute(*d))(o, 0, 2, 1, 3).reshape(B, S, H * Dh) @ wo

    x = A_q
    g = _sigmoid((x * gate_w).sum(-1, keepdims=True))
    a = _A_ref(x, A_k, A_v, A_shift_k, A_ssm_k, A_ssm_D)
    b = _B_ref(x, B_wq, B_wk, B_wv, B_wo)
    return g * a + (1 - g) * b
```

```asm
; @launch grid=(256,1,1) block=(512,1,1) lds=163840
.amdgcn_target "amdgcn-amd-amdhsa--gfx950"
.text
.globl gated_mix__ssm_conv_h3__grouped_kv_mqa__prompt_kernel
.p2align 8
.type gated_mix__ssm_conv_h3__grouped_kv_mqa__prompt_kernel,@function
gated_mix__ssm_conv_h3__grouped_kv_mqa__prompt_kernel:
    s_cmp_ge_u32 s2, 256
    s_cbranch_scc1 MK_END
    s_load_dwordx8 s[4:11], s[0:1], 0
    s_load_dwordx4 s[12:15], s[0:1], 32
    s_load_dwordx8 s[16:23], s[0:1], 56
    s_load_dwordx8 s[24:31], s[0:1], 88
    v_and_b32 v1, 63, v0
    v_lshrrev_b32 v2, 6, v0
    s_nop 0
    v_readfirstlane_b32 s72, v2
    s_and_b32 s77, s2, 7
    s_lshr_b32 s78, s2, 3
    s_lshr_b32 s73, s77, 1
    s_lshl_b32 s73, s73, 2
    s_and_b32 s74, s77, 1
    s_lshl_b32 s74, s74, 3
    s_lshr_b32 s77, s78, 3
    s_add_u32 s73, s73, s77
    s_and_b32 s77, s78, 7
    s_add_u32 s74, s74, s77
    s_and_b32 s75, s72, 3
    s_lshr_b32 s76, s72, 2
    s_and_b32 s77, s74, 7
    s_lshl_b32 s77, s77, 1
    s_and_b32 s78, s73, 3
    s_lshl_b32 s78, s78, 2
    s_add_u32 s68, s77, s78
    s_lshl_b32 s77, s73, 7
    s_lshl_b32 s78, s75, 5
    s_add_u32 s77, s77, s78
    v_lshrrev_b32 v2, 3, v1
    v_add_u32 v2, s77, v2
    v_lshlrev_b32 v2, 11, v2
    v_lshrrev_b32 v3, 4, v1
    v_and_b32 v4, 7, v1
    v_xor_b32 v6, v4, v3
    v_xor_b32 v7, 4, v6
    v_lshlrev_b32 v6, 4, v6
    v_lshlrev_b32 v7, 4, v7
    v_add_u32 v6, v6, v2
    v_add_u32 v7, v7, v2
    v_add_u32 v7, 16384, v7
    s_lshl_b32 s77, s75, 4
    v_lshrrev_b32 v2, 3, v1
    v_add_u32 v2, s77, v2
    v_lshlrev_b32 v2, 11, v2
    v_and_b32 v3, 1, v3
    v_lshlrev_b32 v3, 2, v3
    v_xor_b32 v3, v4, v3
    v_lshlrev_b32 v3, 4, v3
    v_add_u32 v2, v2, v3
    s_lshl_b32 s77, s74, 7
    v_add_u32 v8, s77, v2
    s_lshl_b32 s3, s75, 12
    s_waitcnt lgkmcnt(0)
    s_mov_b32 s0, s68
    s_mov_b32 s60, s30
    s_mov_b32 s61, s31
    s_mov_b32 s62, 0xc94000
    s_mov_b32 s63, 0x20000
    s_mov_b32 s56, s28
    s_mov_b32 s57, s29
    s_mov_b32 s58, 0x100
    s_mov_b32 s59, 0x20000
    s_mov_b32 s32, s4
    s_mov_b32 s33, s5
    s_mov_b32 s34, 0x400000
    s_mov_b32 s35, 0x20000
    s_or_b32 s77, s2, s72
    s_cmp_eq_u32 s77, 0
    s_cbranch_scc0 MK_NOZERO
    v_lshlrev_b32 v2, 8, v1
    v_mov_b32 v3, 0
    s_mov_b32 s78, 13172736
    buffer_store_dword v3, v2, s[60:63], s78 offen sc1
MK_NOZERO:
    s_and_b32 s69, s74, 1
    s_cmp_eq_u32 s69, 0
    s_cselect_b32 s40, s18, s20
    s_cselect_b32 s41, s19, s21
    s_mov_b32 s42, 0x10000
    s_mov_b32 s43, 0x20000
    s_mov_b32 s52, s24
    s_mov_b32 s53, s25
    s_mov_b32 s54, 0x800
    s_mov_b32 s55, 0x20000
    s_cmp_ge_u32 s72, 4
    s_cbranch_scc1 MK_P0P
    v_lshlrev_b32 v2, 4, v1
    s_lshl_b32 s79, s75, 14
    s_add_u32 m0, s79, 98304
    s_add_u32 s77, s79, 0
    buffer_load_dwordx4 v2, s[40:43], s77 offen lds
    s_add_u32 m0, s79, 99328
    s_add_u32 s77, s79, 1024
    buffer_load_dwordx4 v2, s[40:43], s77 offen lds
    s_add_u32 m0, s79, 100352
    s_add_u32 s77, s79, 2048
    buffer_load_dwordx4 v2, s[40:43], s77 offen lds
    s_add_u32 m0, s79, 101376
    s_add_u32 s77, s79, 3072
    buffer_load_dwordx4 v2, s[40:43], s77 offen lds
    s_add_u32 m0, s79, 102400
    s_add_u32 s77, s79, 4096
    buffer_load_dwordx4 v2, s[40:43], s77 offen lds
    s_add_u32 m0, s79, 103424
    s_add_u32 s77, s79, 5120
    buffer_load_dwordx4 v2, s[40:43], s77 offen lds
    s_add_u32 m0, s79, 104448
    s_add_u32 s77, s79, 6144
    buffer_load_dwordx4 v2, s[40:43], s77 offen lds
    s_add_u32 m0, s79, 105472
    s_add_u32 s77, s79, 7168
    buffer_load_dwordx4 v2, s[40:43], s77 offen lds
    s_add_u32 m0, s79, 106496
    s_add_u32 s77, s79, 8192
    buffer_load_dwordx4 v2, s[40:43], s77 offen lds
    s_add_u32 m0, s79, 107520
    s_add_u32 s77, s79, 9216
    buffer_load_dwordx4 v2, s[40:43], s77 offen lds
    s_add_u32 m0, s79, 108544
    s_add_u32 s77, s79, 10240
    buffer_load_dwordx4 v2, s[40:43], s77 offen lds
    s_add_u32 m0, s79, 109568
    s_add_u32 s77, s79, 11264
    buffer_load_dwordx4 v2, s[40:43], s77 offen lds
    s_add_u32 m0, s79, 110592
    s_add_u32 s77, s79, 12288
    buffer_load_dwordx4 v2, s[40:43], s77 offen lds
    s_add_u32 m0, s79, 111616
    s_add_u32 s77, s79, 13312
    buffer_load_dwordx4 v2, s[40:43], s77 offen lds
    s_add_u32 m0, s79, 112640
    s_add_u32 s77, s79, 14336
    buffer_load_dwordx4 v2, s[40:43], s77 offen lds
    s_add_u32 m0, s79, 113664
    s_add_u32 s77, s79, 15360
    buffer_load_dwordx4 v2, s[40:43], s77 offen lds
    s_lshl_b32 s77, s73, 7
    s_lshr_b32 s78, s74, 1
    s_lshl_b32 s78, s78, 4
    s_add_u32 s77, s77, s78
    v_and_b32 v3, 15, v1
    v_add_u32 v3, s77, v3
    v_lshlrev_b32 v3, 11, v3
    v_lshrrev_b32 v4, 4, v1
    v_lshlrev_b32 v4, 4, v4
    s_lshl_b32 s77, s75, 9
    v_add_u32 v4, s77, v4
    v_add_u32 v3, v3, v4
    buffer_load_dwordx4 v[52:55], v3, s[32:35], 0 offen offset:0
    buffer_load_dwordx4 v[56:59], v3, s[32:35], 0 offen offset:64
    buffer_load_dwordx4 v[60:63], v3, s[32:35], 0 offen offset:128
    buffer_load_dwordx4 v[64:67], v3, s[32:35], 0 offen offset:192
    buffer_load_dwordx4 v[68:71], v3, s[32:35], 0 offen offset:256
    buffer_load_dwordx4 v[72:75], v3, s[32:35], 0 offen offset:320
    buffer_load_dwordx4 v[76:79], v3, s[32:35], 0 offen offset:384
    buffer_load_dwordx4 v[80:83], v3, s[32:35], 0 offen offset:448
    s_mov_b32 exec_lo, 0x00010001
    s_mov_b32 exec_hi, 0x00010001
    buffer_load_dwordx4 v[84:87], v4, s[52:55], 0 offen offset:0
    buffer_load_dwordx4 v[88:91], v4, s[52:55], 0 offen offset:64
    buffer_load_dwordx4 v[92:95], v4, s[52:55], 0 offen offset:128
    buffer_load_dwordx4 v[96:99], v4, s[52:55], 0 offen offset:192
    buffer_load_dwordx4 v[100:103], v4, s[52:55], 0 offen offset:256
    buffer_load_dwordx4 v[104:107], v4, s[52:55], 0 offen offset:320
    buffer_load_dwordx4 v[108:111], v4, s[52:55], 0 offen offset:384
    buffer_load_dwordx4 v[112:115], v4, s[52:55], 0 offen offset:448
    s_mov_b64 exec, -1
    v_and_b32 v2, 31, v1
    v_lshrrev_b32 v3, 1, v2
    v_and_b32 v3, 7, v3
    v_lshrrev_b32 v4, 5, v1
    v_xor_b32 v3, v3, v4
    v_lshlrev_b32 v3, 4, v3
    s_lshl_b32 s77, s75, 5
    v_add_u32 v2, s77, v2
    v_lshlrev_b32 v2, 7, v2
    v_add_u32 v2, v2, v3
    v_mov_b32 v10, v2
    v_xor_b32 v11, 32, v10
    v_xor_b32 v12, 64, v10
    v_xor_b32 v13, 96, v10
    v_add_u32 v204, 65536, v10
    v_add_u32 v205, 65536, v11
    v_add_u32 v206, 65536, v12
    v_add_u32 v207, 65536, v13
    v_add_u32 v208, 131072, v10
    v_add_u32 v209, 131072, v11
    v_add_u32 v210, 131072, v12
    v_add_u32 v211, 131072, v13
    v_and_b32 v2, 15, v1
    v_lshrrev_b32 v3, 5, v1
    v_lshlrev_b32 v3, 3, v3
    v_lshrrev_b32 v4, 2, v2
    v_add_u32 v3, v3, v4
    v_lshlrev_b32 v3, 7, v3
    v_bfe_u32 v4, v1, 4, 1
    v_lshlrev_b32 v4, 1, v4
    v_bfe_u32 v5, v2, 1, 1
    v_add_u32 v4, v4, v5
    v_bfe_u32 v5, v2, 3, 1
    v_lshlrev_b32 v5, 2, v5
    v_xor_b32 v4, v4, v5
    v_lshlrev_b32 v4, 4, v4
    v_add_u32 v3, v3, v4
    v_and_b32 v4, 1, v2
    v_lshlrev_b32 v4, 3, v4
    v_add_u32 v3, v3, v4
    v_mov_b32 v14, v3
    v_xor_b32 v15, 64, v14
    v_add_u32 v212, 61440, v14
    v_add_u32 v213, 61440, v15
    v_add_u32 v214, 122880, v14
    v_add_u32 v215, 122880, v15
    v_and_b32 v2, 15, v1
    v_lshrrev_b32 v3, 2, v2
    v_lshrrev_b32 v4, 4, v1
    v_lshlrev_b32 v4, 3, v4
    v_add_u32 v3, v3, v4
    v_lshlrev_b32 v3, 6, v3
    v_and_b32 v2, 3, v2
    v_lshlrev_b32 v2, 3, v2
    v_add_u32 v3, v3, v2
    s_lshl_b32 s77, s75, 14
    s_add_u32 s77, s77, 98304
    v_add_u32 v18, s77, v3
    s_mov_b32 s66, s69
    s_waitcnt vmcnt(0)
    s_or_b32 s77, s2, s72
    s_cmp_eq_u32 s77, 0
    s_cbranch_scc0 MK_NOFLAG0
    v_mov_b32 v2, 0
    v_mov_b32 v3, 1
    s_mov_b32 exec_lo, 0x1
    s_mov_b32 exec_hi, 0
    buffer_store_dword v3, v2, s[56:59], 0 offen sc1
    s_mov_b64 exec, -1
MK_NOFLAG0:
    ds_read_b64_tr_b16 v[116:117], v18 offset:0
    ds_read_b64_tr_b16 v[118:119], v18 offset:256
    ds_read_b64_tr_b16 v[120:121], v18 offset:32
    ds_read_b64_tr_b16 v[122:123], v18 offset:288
    ds_read_b64_tr_b16 v[124:125], v18 offset:2048
    ds_read_b64_tr_b16 v[126:127], v18 offset:2304
    ds_read_b64_tr_b16 v[128:129], v18 offset:2080
    ds_read_b64_tr_b16 v[130:131], v18 offset:2336
    ds_read_b64_tr_b16 v[132:133], v18 offset:4096
    ds_read_b64_tr_b16 v[134:135], v18 offset:4352
    ds_read_b64_tr_b16 v[136:137], v18 offset:4128
    ds_read_b64_tr_b16 v[138:139], v18 offset:4384
    ds_read_b64_tr_b16 v[140:141], v18 offset:6144
    ds_read_b64_tr_b16 v[142:143], v18 offset:6400
    ds_read_b64_tr_b16 v[144:145], v18 offset:6176
    ds_read_b64_tr_b16 v[146:147], v18 offset:6432
    ds_read_b64_tr_b16 v[148:149], v18 offset:8192
    ds_read_b64_tr_b16 v[150:151], v18 offset:8448
    ds_read_b64_tr_b16 v[152:153], v18 offset:8224
    ds_read_b64_tr_b16 v[154:155], v18 offset:8480
    ds_read_b64_tr_b16 v[156:157], v18 offset:10240
    ds_read_b64_tr_b16 v[158:159], v18 offset:10496
    ds_read_b64_tr_b16 v[160:161], v18 offset:10272
    ds_read_b64_tr_b16 v[162:163], v18 offset:10528
    ds_read_b64_tr_b16 v[164:165], v18 offset:12288
    ds_read_b64_tr_b16 v[166:167], v18 offset:12544
    ds_read_b64_tr_b16 v[168:169], v18 offset:12320
    ds_read_b64_tr_b16 v[170:171], v18 offset:12576
    ds_read_b64_tr_b16 v[172:173], v18 offset:14336
    ds_read_b64_tr_b16 v[174:175], v18 offset:14592
    ds_read_b64_tr_b16 v[176:177], v18 offset:14368
    ds_read_b64_tr_b16 v[178:179], v18 offset:14624
    s_waitcnt lgkmcnt(0)
    s_cmp_eq_u32 s66, 0
    s_cbranch_scc0 MK_P0V1
    v_mfma_f32_16x16x32_bf16 v[180:183], v[116:119], v[52:55], 0
    v_mfma_f32_16x16x32_bf16 v[184:187], v[120:123], v[52:55], 0
    v_mfma_f32_16x16x32_bf16 v[188:191], v[84:87], v[52:55], 0
    v_mfma_f32_16x16x32_bf16 v[180:183], v[124:127], v[56:59], v[180:183]
    v_mfma_f32_16x16x32_bf16 v[184:187], v[128:131], v[56:59], v[184:187]
    v_mfma_f32_16x16x32_bf16 v[188:191], v[88:91], v[56:59], v[188:191]
    v_mfma_f32_16x16x32_bf16 v[180:183], v[132:135], v[60:63], v[180:183]
    v_mfma_f32_16x16x32_bf16 v[184:187], v[136:139], v[60:63], v[184:187]
    v_mfma_f32_16x16x32_bf16 v[188:191], v[92:95], v[60:63], v[188:191]
    v_mfma_f32_16x16x32_bf16 v[180:183], v[140:143], v[64:67], v[180:183]
    v_mfma_f32_16x16x32_bf16 v[184:187], v[144:147], v[64:67], v[184:187]
    v_mfma_f32_16x16x32_bf16 v[188:191], v[96:99], v[64:67], v[188:191]
    v_mfma_f32_16x16x32_bf16 v[180:183], v[148:151], v[68:71], v[180:183]
    v_mfma_f32_16x16x32_bf16 v[184:187], v[152:155], v[68:71], v[184:187]
    v_mfma_f32_16x16x32_bf16 v[188:191], v[100:103], v[68:71], v[188:191]
    v_mfma_f32_16x16x32_bf16 v[180:183], v[156:159], v[72:75], v[180:183]
    v_mfma_f32_16x16x32_bf16 v[184:187], v[160:163], v[72:75], v[184:187]
    v_mfma_f32_16x16x32_bf16 v[188:191], v[104:107], v[72:75], v[188:191]
    v_mfma_f32_16x16x32_bf16 v[180:183], v[164:167], v[76:79], v[180:183]
    v_mfma_f32_16x16x32_bf16 v[184:187], v[168:171], v[76:79], v[184:187]
    v_mfma_f32_16x16x32_bf16 v[188:191], v[108:111], v[76:79], v[188:191]
    v_mfma_f32_16x16x32_bf16 v[180:183], v[172:175], v[80:83], v[180:183]
    v_mfma_f32_16x16x32_bf16 v[184:187], v[176:179], v[80:83], v[184:187]
    v_mfma_f32_16x16x32_bf16 v[188:191], v[112:115], v[80:83], v[188:191]
    s_branch MK_P0V1W
MK_P0V1:
    v_mfma_f32_16x16x32_bf16 v[180:183], v[52:55], v[116:119], 0
    v_mfma_f32_16x16x32_bf16 v[184:187], v[52:55], v[120:123], 0
    v_mfma_f32_16x16x32_bf16 v[180:183], v[56:59], v[124:127], v[180:183]
    v_mfma_f32_16x16x32_bf16 v[184:187], v[56:59], v[128:131], v[184:187]
    v_mfma_f32_16x16x32_bf16 v[180:183], v[60:63], v[132:135], v[180:183]
    v_mfma_f32_16x16x32_bf16 v[184:187], v[60:63], v[136:139], v[184:187]
    v_mfma_f32_16x16x32_bf16 v[180:183], v[64:67], v[140:143], v[180:183]
    v_mfma_f32_16x16x32_bf16 v[184:187], v[64:67], v[144:147], v[184:187]
    v_mfma_f32_16x16x32_bf16 v[180:183], v[68:71], v[148:151], v[180:183]
    v_mfma_f32_16x16x32_bf16 v[184:187], v[68:71], v[152:155], v[184:187]
    v_mfma_f32_16x16x32_bf16 v[180:183], v[72:75], v[156:159], v[180:183]
    v_mfma_f32_16x16x32_bf16 v[184:187], v[72:75], v[160:163], v[184:187]
    v_mfma_f32_16x16x32_bf16 v[180:183], v[76:79], v[164:167], v[180:183]
    v_mfma_f32_16x16x32_bf16 v[184:187], v[76:79], v[168:171], v[184:187]
    v_mfma_f32_16x16x32_bf16 v[180:183], v[80:83], v[172:175], v[180:183]
    v_mfma_f32_16x16x32_bf16 v[184:187], v[80:83], v[176:179], v[184:187]
    v_mov_b32 v188, 0
    v_mov_b32 v189, 0
    v_mov_b32 v190, 0
    v_mov_b32 v191, 0
MK_P0V1W:
    s_nop 7
    s_nop 1
    v_lshlrev_b32 v2, 4, v1
    s_lshl_b32 s77, s75, 14
    s_add_u32 s77, s77, 98304
    v_add_u32 v2, s77, v2
    ds_write_b128 v2, v[180:183] offset:0
    ds_write_b128 v2, v[184:187] offset:1024
    ds_write_b128 v2, v[188:191] offset:2048
    s_waitcnt lgkmcnt(0)
    s_barrier
    s_branch MK_P1C
MK_P0P:
    s_mov_b32 s36, s16
    s_mov_b32 s37, s17
    s_mov_b32 s38, 0x200000
    s_mov_b32 s39, 0x20000
    s_add_u32 s70, s68, 0
    s_and_b32 s70, s70, 15
    s_lshl_b32 s70, s70, 7
    s_add_u32 m0, s3, 0
    s_add_u32 s77, s70, 0
    buffer_load_dwordx4 v6, s[32:35], s77 offen lds
    s_add_u32 m0, s3, 1024
    s_add_u32 s77, s70, 0
    buffer_load_dwordx4 v7, s[32:35], s77 offen lds
    s_add_u32 m0, s3, 2048
    s_add_u32 s77, s70, 32768
    buffer_load_dwordx4 v6, s[32:35], s77 offen lds
    s_add_u32 m0, s3, 3072
    s_add_u32 s77, s70, 32768
    buffer_load_dwordx4 v7, s[32:35], s77 offen lds
    s_add_u32 s71, s68, 0
    s_and_b32 s71, s71, 15
    s_lshl_b32 s71, s71, 17
    s_lshr_b32 s78, s3, 1
    s_add_u32 m0, s78, 16384
    s_add_u32 s78, s71, 0
    buffer_load_dwordx4 v8, s[36:39], s78 offen lds
    s_lshr_b32 s78, s3, 1
    s_add_u32 m0, s78, 17408
    s_add_u32 s78, s71, 16384
    buffer_load_dwordx4 v8, s[36:39], s78 offen lds
    s_add_u32 s70, s68, 1
    s_and_b32 s70, s70, 15
    s_lshl_b32 s70, s70, 7
    s_add_u32 m0, s3, 24576
    s_add_u32 s77, s70, 0
    buffer_load_dwordx4 v6, s[32:35], s77 offen lds
    s_add_u32 m0, s3, 25600
    s_add_u32 s77, s70, 0
    buffer_load_dwordx4 v7, s[32:35], s77 offen lds
    s_add_u32 m0, s3, 26624
    s_add_u32 s77, s70, 32768
    buffer_load_dwordx4 v6, s[32:35], s77 offen lds
    s_add_u32 m0, s3, 27648
    s_add_u32 s77, s70, 32768
    buffer_load_dwordx4 v7, s[32:35], s77 offen lds
    s_add_u32 s71, s68, 1
    s_and_b32 s71, s71, 15
    s_lshl_b32 s71, s71, 17
    s_lshr_b32 s78, s3, 1
    s_add_u32 m0, s78, 40960
    s_add_u32 s78, s71, 0
    buffer_load_dwordx4 v8, s[36:39], s78 offen lds
    s_lshr_b32 s78, s3, 1
    s_add_u32 m0, s78, 41984
    s_add_u32 s78, s71, 16384
    buffer_load_dwordx4 v8, s[36:39], s78 offen lds
    s_add_u32 s70, s68, 2
    s_and_b32 s70, s70, 15
    s_lshl_b32 s70, s70, 7
    s_add_u32 m0, s3, 49152
    s_add_u32 s77, s70, 0
    buffer_load_dwordx4 v6, s[32:35], s77 offen lds
    s_add_u32 m0, s3, 50176
    s_add_u32 s77, s70, 0
    buffer_load_dwordx4 v7, s[32:35], s77 offen lds
    s_add_u32 m0, s3, 51200
    s_add_u32 s77, s70, 32768
    buffer_load_dwordx4 v6, s[32:35], s77 offen lds
    s_add_u32 m0, s3, 52224
    s_add_u32 s77, s70, 32768
    buffer_load_dwordx4 v7, s[32:35], s77 offen lds
    s_add_u32 s71, s68, 2
    s_and_b32 s71, s71, 15
    s_lshl_b32 s71, s71, 17
    s_lshr_b32 s78, s3, 1
    s_add_u32 m0, s78, 65536
    s_add_u32 s78, s71, 0
    buffer_load_dwordx4 v8, s[36:39], s78 offen lds
    s_lshr_b32 s78, s3, 1
    s_add_u32 m0, s78, 66560
    s_add_u32 s78, s71, 16384
    buffer_load_dwordx4 v8, s[36:39], s78 offen lds
    s_add_u32 s70, s68, 3
    s_and_b32 s70, s70, 15
    s_lshl_b32 s70, s70, 7
    s_add_u32 m0, s3, 73728
    s_add_u32 s77, s70, 0
    buffer_load_dwordx4 v6, s[32:35], s77 offen lds
    s_add_u32 m0, s3, 74752
    s_add_u32 s77, s70, 0
    buffer_load_dwordx4 v7, s[32:35], s77 offen lds
    s_add_u32 m0, s3, 75776
    s_add_u32 s77, s70, 32768
    buffer_load_dwordx4 v6, s[32:35], s77 offen lds
    s_add_u32 m0, s3, 76800
    s_add_u32 s77, s70, 32768
    buffer_load_dwordx4 v7, s[32:35], s77 offen lds
    s_add_u32 s71, s68, 3
    s_and_b32 s71, s71, 15
    s_lshl_b32 s71, s71, 17
    s_lshr_b32 s78, s3, 1
    s_add_u32 m0, s78, 90112
    s_add_u32 s78, s71, 0
    buffer_load_dwordx4 v8, s[36:39], s78 offen lds
    s_lshr_b32 s78, s3, 1
    s_add_u32 m0, s78, 91136
    s_add_u32 s78, s71, 16384
    buffer_load_dwordx4 v8, s[36:39], s78 offen lds
    s_barrier
    s_cmp_lt_u32 s75, 3
    s_cbranch_scc0 MK_NORED
    v_lshlrev_b32 v2, 4, v1
    s_lshl_b32 s77, s75, 10
    s_add_u32 s77, s77, 98304
    v_add_u32 v2, s77, v2
    ds_read_b128 v[20:23], v2 offset:0
    ds_read_b128 v[24:27], v2 offset:16384
    ds_read_b128 v[28:31], v2 offset:32768
    ds_read_b128 v[32:35], v2 offset:49152
    s_waitcnt lgkmcnt(0)
    v_add_f32 v20, v20, v24
    v_add_f32 v21, v21, v25
    v_add_f32 v22, v22, v26
    v_add_f32 v23, v23, v27
    v_add_f32 v20, v20, v28
    v_add_f32 v21, v21, v29
    v_add_f32 v22, v22, v30
    v_add_f32 v23, v23, v31
    v_add_f32 v20, v20, v32
    v_add_f32 v21, v21, v33
    v_add_f32 v22, v22, v34
    v_add_f32 v23, v23, v35
MK_NORED:
    v_mov_b32 v2, 0
    buffer_load_dword v60, v2, s[56:59], 0 offen sc1
    s_mov_b32 s1, 0
    s_waitcnt vmcnt(19)
    s_barrier
    s_cmp_lt_u32 s75, 3
    s_cbranch_scc0 MK_KVF_D
    s_cmp_eq_u32 s75, 2
    s_cbranch_scc1 MK_KVF_G
    v_cvt_pk_bf16_f32 v24, v20, v21
    v_cvt_pk_bf16_f32 v25, v22, v23
    s_lshl_b32 s77, s73, 2
    s_lshr_b32 s78, s74, 2
    s_add_u32 s77, s77, s78
    s_lshl_b32 s77, s77, 12
    s_add_u32 s77, s77, 12845056
    s_bfe_u32 s78, s74, 0x10001
    s_cmp_eq_u32 s69, 0
    s_cbranch_scc0 MK_KVF_V
    s_lshl_b32 s78, s78, 8
    s_add_u32 s77, s77, s78
    s_lshl_b32 s78, s75, 10
    s_add_u32 s77, s77, s78
    v_and_b32 v2, 15, v1
    v_lshlrev_b32 v2, 4, v2
    v_bfe_u32 v3, v1, 4, 1
    v_lshlrev_b32 v3, 9, v3
    v_add_u32 v2, v2, v3
    v_lshrrev_b32 v3, 5, v1
    v_lshlrev_b32 v3, 3, v3
    v_add_u32 v2, v2, v3
    s_branch MK_KVF_S
MK_KVF_V:
    s_lshl_b32 s78, s78, 10
    s_add_u32 s77, s77, s78
    s_lshl_b32 s78, s75, 8
    s_add_u32 s77, s77, s78
    s_add_u32 s77, s77, 2048
    v_and_b32 v2, 15, v1
    v_lshlrev_b32 v2, 4, v2
    v_lshrrev_b32 v3, 5, v1
    v_lshlrev_b32 v3, 9, v3
    v_add_u32 v2, v2, v3
    v_bfe_u32 v3, v1, 4, 1
    v_lshlrev_b32 v3, 3, v3
    v_add_u32 v2, v2, v3
MK_KVF_S:
    buffer_store_dwordx2 v[24:25], v2, s[60:63], s77 offen sc1
    s_branch MK_KVF_D
MK_KVF_G:
    s_cmp_eq_u32 s69, 0
    s_cbranch_scc0 MK_KVF_D
    v_cvt_pk_bf16_f32 v20, v20, v20
    v_lshlrev_b32 v20, 16, v20
    v_mul_f32 v20, 0xbfb8aa3b, v20
    v_exp_f32 v20, v20
    s_nop 0
    v_add_f32 v20, 1.0, v20
    v_rcp_f32 v20, v20
    s_nop 0
    v_cvt_pk_bf16_f32 v20, v20, v20
    v_lshlrev_b32 v20, 16, v20
    v_sub_f32 v21, 1.0, v20
    v_cvt_pk_bf16_f32 v21, v21, v21
    v_lshlrev_b32 v21, 16, v21
    s_lshl_b32 s77, s73, 7
    s_lshr_b32 s78, s74, 1
    s_lshl_b32 s78, s78, 4
    s_add_u32 s77, s77, s78
    s_lshl_b32 s77, s77, 3
    s_add_u32 s77, s77, 13107200
    v_lshlrev_b32 v2, 3, v1
    s_mov_b32 exec_lo, 0xffff
    s_mov_b32 exec_hi, 0
    buffer_store_dwordx2 v[20:21], v2, s[60:63], s77 offen sc1
    s_mov_b64 exec, -1
MK_KVF_D:
    s_add_u32 s70, s68, 4
    s_and_b32 s70, s70, 15
    s_lshl_b32 s70, s70, 7
    s_add_u32 m0, s3, 98304
    s_add_u32 s77, s70, 0
    buffer_load_dwordx4 v6, s[32:35], s77 offen lds
    s_add_u32 m0, s3, 99328
    s_add_u32 s77, s70, 0
    buffer_load_dwordx4 v7, s[32:35], s77 offen lds
    s_add_u32 m0, s3, 100352
    s_add_u32 s77, s70, 32768
    buffer_load_dwordx4 v6, s[32:35], s77 offen lds
    s_add_u32 m0, s3, 101376
    s_add_u32 s77, s70, 32768
    buffer_load_dwordx4 v7, s[32:35], s77 offen lds
    s_add_u32 s71, s68, 4
    s_and_b32 s71, s71, 15
    s_lshl_b32 s71, s71, 17
    s_lshr_b32 s78, s3, 1
    s_add_u32 m0, s78, 114688
    s_add_u32 s78, s71, 0
    buffer_load_dwordx4 v8, s[36:39], s78 offen lds
    s_lshr_b32 s78, s3, 1
    s_add_u32 m0, s78, 115712
    s_add_u32 s78, s71, 16384
    buffer_load_dwordx4 v8, s[36:39], s78 offen lds
    v_lshrrev_b32 v2, 5, v1
    s_lshl_b32 s77, s75, 2
    v_add_u32 v2, s77, v2
    v_lshlrev_b32 v2, 10, v2
    v_and_b32 v3, 31, v1
    v_lshlrev_b32 v3, 2, v3
    v_add_u32 v180, v2, v3
    v_add_u32 v180, 122880, v180
    s_waitcnt vmcnt(19)
    s_barrier
    s_add_u32 s70, s68, 5
    s_and_b32 s70, s70, 15
    s_lshl_b32 s70, s70, 7
    s_add_u32 m0, s3, 0
    s_add_u32 s77, s70, 0
    buffer_load_dwordx4 v6, s[32:35], s77 offen lds
    s_add_u32 m0, s3, 1024
    s_add_u32 s77, s70, 0
    buffer_load_dwordx4 v7, s[32:35], s77 offen lds
    s_add_u32 m0, s3, 2048
    s_add_u32 s77, s70, 32768
    buffer_load_dwordx4 v6, s[32:35], s77 offen lds
    s_add_u32 m0, s3, 3072
    s_add_u32 s77, s70, 32768
    buffer_load_dwordx4 v7, s[32:35], s77 offen lds
    s_add_u32 s71, s68, 5
    s_and_b32 s71, s71, 15
    s_lshl_b32 s71, s71, 17
    s_lshr_b32 s78, s3, 1
    s_add_u32 m0, s78, 16384
    s_add_u32 s78, s71, 0
    buffer_load_dwordx4 v8, s[36:39], s78 offen lds
    s_lshr_b32 s78, s3, 1
    s_add_u32 m0, s78, 17408
    s_add_u32 s78, s71, 16384
    buffer_load_dwordx4 v8, s[36:39], s78 offen lds
    s_waitcnt vmcnt(19)
    s_barrier
    s_add_u32 s70, s68, 6
    s_and_b32 s70, s70, 15
    s_lshl_b32 s70, s70, 7
    s_add_u32 m0, s3, 24576
    s_add_u32 s77, s70, 0
    buffer_load_dwordx4 v6, s[32:35], s77 offen lds
    s_add_u32 m0, s3, 25600
    s_add_u32 s77, s70, 0
    buffer_load_dwordx4 v7, s[32:35], s77 offen lds
    s_add_u32 m0, s3, 26624
    s_add_u32 s77, s70, 32768
    buffer_load_dwordx4 v6, s[32:35], s77 offen lds
    s_add_u32 m0, s3, 27648
    s_add_u32 s77, s70, 32768
    buffer_load_dwordx4 v7, s[32:35], s77 offen lds
    s_add_u32 s71, s68, 6
    s_and_b32 s71, s71, 15
    s_lshl_b32 s71, s71, 17
    s_lshr_b32 s78, s3, 1
    s_add_u32 m0, s78, 40960
    s_add_u32 s78, s71, 0
    buffer_load_dwordx4 v8, s[36:39], s78 offen lds
    s_lshr_b32 s78, s3, 1
    s_add_u32 m0, s78, 41984
    s_add_u32 s78, s71, 16384
    buffer_load_dwordx4 v8, s[36:39], s78 offen lds
    s_waitcnt vmcnt(19)
    s_barrier
    s_add_u32 s70, s68, 7
    s_and_b32 s70, s70, 15
    s_lshl_b32 s70, s70, 7
    s_add_u32 m0, s3, 49152
    s_add_u32 s77, s70, 0
    buffer_load_dwordx4 v6, s[32:35], s77 offen lds
    s_add_u32 m0, s3, 50176
    s_add_u32 s77, s70, 0
    buffer_load_dwordx4 v7, s[32:35], s77 offen lds
    s_add_u32 m0, s3, 51200
    s_add_u32 s77, s70, 32768
    buffer_load_dwordx4 v6, s[32:35], s77 offen lds
    s_add_u32 m0, s3, 52224
    s_add_u32 s77, s70, 32768
    buffer_load_dwordx4 v7, s[32:35], s77 offen lds
    s_add_u32 s71, s68, 7
    s_and_b32 s71, s71, 15
    s_lshl_b32 s71, s71, 17
    s_lshr_b32 s78, s3, 1
    s_add_u32 m0, s78, 65536
    s_add_u32 s78, s71, 0
    buffer_load_dwordx4 v8, s[36:39], s78 offen lds
    s_lshr_b32 s78, s3, 1
    s_add_u32 m0, s78, 66560
    s_add_u32 s78, s71, 16384
    buffer_load_dwordx4 v8, s[36:39], s78 offen lds
    s_waitcnt vmcnt(18)
    s_barrier
    s_add_u32 s70, s68, 8
    s_and_b32 s70, s70, 15
    s_lshl_b32 s70, s70, 7
    s_add_u32 m0, s3, 73728
    s_add_u32 s77, s70, 0
    buffer_load_dwordx4 v6, s[32:35], s77 offen lds
    s_add_u32 m0, s3, 74752
    s_add_u32 s77, s70, 0
    buffer_load_dwordx4 v7, s[32:35], s77 offen lds
    s_add_u32 m0, s3, 75776
    s_add_u32 s77, s70, 32768
    buffer_load_dwordx4 v6, s[32:35], s77 offen lds
    s_add_u32 m0, s3, 76800
    s_add_u32 s77, s70, 32768
    buffer_load_dwordx4 v7, s[32:35], s77 offen lds
    s_add_u32 s71, s68, 8
    s_and_b32 s71, s71, 15
    s_lshl_b32 s71, s71, 17
    s_lshr_b32 s78, s3, 1
    s_add_u32 m0, s78, 90112
    s_add_u32 s78, s71, 0
    buffer_load_dwordx4 v8, s[36:39], s78 offen lds
    s_lshr_b32 s78, s3, 1
    s_add_u32 m0, s78, 91136
    s_add_u32 s78, s71, 16384
    buffer_load_dwordx4 v8, s[36:39], s78 offen lds
    s_cmp_eq_u32 s72, 4
    s_cbranch_scc0 MK_NOARRB
    v_readfirstlane_b32 s77, v60
    s_nop 3
    s_cmp_ge_u32 s77, 1
    s_cbranch_scc1 MK_IFOK
    v_lshlrev_b32 v2, 2, v1
    s_mov_b32 exec_lo, 0x1
    s_mov_b32 exec_hi, 0
    s_mov_b32 s78, 0x20000
MK_POLL2:
    buffer_load_dword v3, v2, s[56:59], 0 offen sc1
    s_waitcnt vmcnt(0)
    v_cmp_gt_u32 vcc, 1, v3
    s_cbranch_vccz MK_POLL2D
    s_sleep 1
    s_sub_u32 s78, s78, 1
    s_cmp_lg_u32 s78, 0
    s_cbranch_scc1 MK_POLL2
MK_POLL2D:
    s_mov_b64 exec, -1
MK_IFOK:
    s_lshr_b32 s79, s73, 1
    s_add_u32 s79, s79, 16
    s_lshl_b32 s77, s79, 8
    s_add_u32 s77, s77, 13172736
    v_mov_b32 v2, 0
    v_mov_b32 v3, 1
    s_mov_b32 exec_lo, 0x1
    s_mov_b32 exec_hi, 0
    buffer_atomic_add v3, v2, s[60:63], s77 offen sc1
    s_mov_b64 exec, -1
MK_NOARRB:
    s_waitcnt vmcnt(18)
    s_barrier
    s_add_u32 s70, s68, 9
    s_and_b32 s70, s70, 15
    s_lshl_b32 s70, s70, 7
    s_add_u32 m0, s3, 98304
    s_add_u32 s77, s70, 0
    buffer_load_dwordx4 v6, s[32:35], s77 offen lds
    s_add_u32 m0, s3, 99328
    s_add_u32 s77, s70, 0
    buffer_load_dwordx4 v7, s[32:35], s77 offen lds
    s_add_u32 m0, s3, 100352
    s_add_u32 s77, s70, 32768
    buffer_load_dwordx4 v6, s[32:35], s77 offen lds
    s_add_u32 m0, s3, 101376
    s_add_u32 s77, s70, 32768
    buffer_load_dwordx4 v7, s[32:35], s77 offen lds
    s_add_u32 s71, s68, 9
    s_and_b32 s71, s71, 15
    s_lshl_b32 s71, s71, 17
    s_lshr_b32 s78, s3, 1
    s_add_u32 m0, s78, 114688
    s_add_u32 s78, s71, 0
    buffer_load_dwordx4 v8, s[36:39], s78 offen lds
    s_lshr_b32 s78, s3, 1
    s_add_u32 m0, s78, 115712
    s_add_u32 s78, s71, 16384
    buffer_load_dwordx4 v8, s[36:39], s78 offen lds
    s_waitcnt vmcnt(18)
    s_barrier
    s_add_u32 s70, s68, 10
    s_and_b32 s70, s70, 15
    s_lshl_b32 s70, s70, 7
    s_add_u32 m0, s3, 0
    s_add_u32 s77, s70, 0
    buffer_load_dwordx4 v6, s[32:35], s77 offen lds
    s_add_u32 m0, s3, 1024
    s_add_u32 s77, s70, 0
    buffer_load_dwordx4 v7, s[32:35], s77 offen lds
    s_add_u32 m0, s3, 2048
    s_add_u32 s77, s70, 32768
    buffer_load_dwordx4 v6, s[32:35], s77 offen lds
    s_add_u32 m0, s3, 3072
    s_add_u32 s77, s70, 32768
    buffer_load_dwordx4 v7, s[32:35], s77 offen lds
    s_add_u32 s71, s68, 10
    s_and_b32 s71, s71, 15
    s_lshl_b32 s71, s71, 17
    s_lshr_b32 s78, s3, 1
    s_add_u32 m0, s78, 16384
    s_add_u32 s78, s71, 0
    buffer_load_dwordx4 v8, s[36:39], s78 offen lds
    s_lshr_b32 s78, s3, 1
    s_add_u32 m0, s78, 17408
    s_add_u32 s78, s71, 16384
    buffer_load_dwordx4 v8, s[36:39], s78 offen lds
    s_waitcnt vmcnt(18)
    s_barrier
    s_add_u32 s70, s68, 11
    s_and_b32 s70, s70, 15
    s_lshl_b32 s70, s70, 7
    s_add_u32 m0, s3, 24576
    s_add_u32 s77, s70, 0
    buffer_load_dwordx4 v6, s[32:35], s77 offen lds
    s_add_u32 m0, s3, 25600
    s_add_u32 s77, s70, 0
    buffer_load_dwordx4 v7, s[32:35], s77 offen lds
    s_add_u32 m0, s3, 26624
    s_add_u32 s77, s70, 32768
    buffer_load_dwordx4 v6, s[32:35], s77 offen lds
    s_add_u32 m0, s3, 27648
    s_add_u32 s77, s70, 32768
    buffer_load_dwordx4 v7, s[32:35], s77 offen lds
    s_add_u32 s71, s68, 11
    s_and_b32 s71, s71, 15
    s_lshl_b32 s71, s71, 17
    s_lshr_b32 s78, s3, 1
    s_add_u32 m0, s78, 40960
    s_add_u32 s78, s71, 0
    buffer_load_dwordx4 v8, s[36:39], s78 offen lds
    s_lshr_b32 s78, s3, 1
    s_add_u32 m0, s78, 41984
    s_add_u32 s78, s71, 16384
    buffer_load_dwordx4 v8, s[36:39], s78 offen lds
    s_waitcnt vmcnt(18)
    s_barrier
    s_add_u32 s70, s68, 12
    s_and_b32 s70, s70, 15
    s_lshl_b32 s70, s70, 7
    s_add_u32 m0, s3, 49152
    s_add_u32 s77, s70, 0
    buffer_load_dwordx4 v6, s[32:35], s77 offen lds
    s_add_u32 m0, s3, 50176
    s_add_u32 s77, s70, 0
    buffer_load_dwordx4 v7, s[32:35], s77 offen lds
    s_add_u32 m0, s3, 51200
    s_add_u32 s77, s70, 32768
    buffer_load_dwordx4 v6, s[32:35], s77 offen lds
    s_add_u32 m0, s3, 52224
    s_add_u32 s77, s70, 32768
    buffer_load_dwordx4 v7, s[32:35], s77 offen lds
    s_add_u32 s71, s68, 12
    s_and_b32 s71, s71, 15
    s_lshl_b32 s71, s71, 17
    s_lshr_b32 s78, s3, 1
    s_add_u32 m0, s78, 65536
    s_add_u32 s78, s71, 0
    buffer_load_dwordx4 v8, s[36:39], s78 offen lds
    s_lshr_b32 s78, s3, 1
    s_add_u32 m0, s78, 66560
    s_add_u32 s78, s71, 16384
    buffer_load_dwordx4 v8, s[36:39], s78 offen lds
    s_waitcnt vmcnt(18)
    s_barrier
    s_add_u32 s70, s68, 13
    s_and_b32 s70, s70, 15
    s_lshl_b32 s70, s70, 7
    s_add_u32 m0, s3, 73728
    s_add_u32 s77, s70, 0
    buffer_load_dwordx4 v6, s[32:35], s77 offen lds
    s_add_u32 m0, s3, 74752
    s_add_u32 s77, s70, 0
    buffer_load_dwordx4 v7, s[32:35], s77 offen lds
    s_add_u32 m0, s3, 75776
    s_add_u32 s77, s70, 32768
    buffer_load_dwordx4 v6, s[32:35], s77 offen lds
    s_add_u32 m0, s3, 76800
    s_add_u32 s77, s70, 32768
    buffer_load_dwordx4 v7, s[32:35], s77 offen lds
    s_add_u32 s71, s68, 13
    s_and_b32 s71, s71, 15
    s_lshl_b32 s71, s71, 17
    s_lshr_b32 s78, s3, 1
    s_add_u32 m0, s78, 90112
    s_add_u32 s78, s71, 0
    buffer_load_dwordx4 v8, s[36:39], s78 offen lds
    s_lshr_b32 s78, s3, 1
    s_add_u32 m0, s78, 91136
    s_add_u32 s78, s71, 16384
    buffer_load_dwordx4 v8, s[36:39], s78 offen lds
    v_lshlrev_b32 v2, 8, v1
    s_mov_b32 s77, 13176832
    s_mov_b32 exec_lo, 0xff
    s_mov_b32 exec_hi, 0
    buffer_load_dword v61, v2, s[60:63], s77 offen sc1
    s_mov_b64 exec, -1
    s_waitcnt vmcnt(19)
    s_barrier
    s_add_u32 s70, s68, 14
    s_and_b32 s70, s70, 15
    s_lshl_b32 s70, s70, 7
    s_add_u32 m0, s3, 98304
    s_add_u32 s77, s70, 0
    buffer_load_dwordx4 v6, s[32:35], s77 offen lds
    s_add_u32 m0, s3, 99328
    s_add_u32 s77, s70, 0
    buffer_load_dwordx4 v7, s[32:35], s77 offen lds
    s_add_u32 m0, s3, 100352
    s_add_u32 s77, s70, 32768
    buffer_load_dwordx4 v6, s[32:35], s77 offen lds
    s_add_u32 m0, s3, 101376
    s_add_u32 s77, s70, 32768
    buffer_load_dwordx4 v7, s[32:35], s77 offen lds
    s_add_u32 s71, s68, 14
    s_and_b32 s71, s71, 15
    s_lshl_b32 s71, s71, 17
    s_lshr_b32 s78, s3, 1
    s_add_u32 m0, s78, 114688
    s_add_u32 s78, s71, 0
    buffer_load_dwordx4 v8, s[36:39], s78 offen lds
    s_lshr_b32 s78, s3, 1
    s_add_u32 m0, s78, 115712
    s_add_u32 s78, s71, 16384
    buffer_load_dwordx4 v8, s[36:39], s78 offen lds
    s_waitcnt vmcnt(19)
    s_barrier
    s_add_u32 s70, s68, 15
    s_and_b32 s70, s70, 15
    s_lshl_b32 s70, s70, 7
    s_add_u32 m0, s3, 0
    s_add_u32 s77, s70, 0
    buffer_load_dwordx4 v6, s[32:35], s77 offen lds
    s_add_u32 m0, s3, 1024
    s_add_u32 s77, s70, 0
    buffer_load_dwordx4 v7, s[32:35], s77 offen lds
    s_add_u32 m0, s3, 2048
    s_add_u32 s77, s70, 32768
    buffer_load_dwordx4 v6, s[32:35], s77 offen lds
    s_add_u32 m0, s3, 3072
    s_add_u32 s77, s70, 32768
    buffer_load_dwordx4 v7, s[32:35], s77 offen lds
    s_add_u32 s71, s68, 15
    s_and_b32 s71, s71, 15
    s_lshl_b32 s71, s71, 17
    s_lshr_b32 s78, s3, 1
    s_add_u32 m0, s78, 16384
    s_add_u32 s78, s71, 0
    buffer_load_dwordx4 v8, s[36:39], s78 offen lds
    s_lshr_b32 s78, s3, 1
    s_add_u32 m0, s78, 17408
    s_add_u32 s78, s71, 16384
    buffer_load_dwordx4 v8, s[36:39], s78 offen lds
    s_waitcnt vmcnt(19)
    s_barrier
    s_waitcnt vmcnt(12)
    s_mov_b32 exec_lo, 0xff
    s_mov_b32 exec_hi, 0
    v_cmp_gt_u32 vcc, 32, v61
    s_mov_b64 exec, -1
    s_cbranch_vccnz MK_NOC0
    s_mov_b32 s1, 1
MK_NOC0:
    v_lshlrev_b32 v2, 4, v1
    s_lshl_b32 s79, s75, 13
    s_add_u32 m0, s79, 122880
    s_add_u32 s77, s79, 12845056
    buffer_load_dwordx4 v2, s[60:63], s77 offen sc1 lds
    s_add_u32 m0, s79, 123904
    s_add_u32 s77, s79, 12846080
    buffer_load_dwordx4 v2, s[60:63], s77 offen sc1 lds
    s_add_u32 m0, s79, 124928
    s_add_u32 s77, s79, 12847104
    buffer_load_dwordx4 v2, s[60:63], s77 offen sc1 lds
    s_add_u32 m0, s79, 125952
    s_add_u32 s77, s79, 12848128
    buffer_load_dwordx4 v2, s[60:63], s77 offen sc1 lds
    s_add_u32 m0, s79, 126976
    s_add_u32 s77, s79, 12849152
    buffer_load_dwordx4 v2, s[60:63], s77 offen sc1 lds
    s_add_u32 m0, s79, 128000
    s_add_u32 s77, s79, 12850176
    buffer_load_dwordx4 v2, s[60:63], s77 offen sc1 lds
    s_add_u32 m0, s79, 129024
    s_add_u32 s77, s79, 12851200
    buffer_load_dwordx4 v2, s[60:63], s77 offen sc1 lds
    s_add_u32 m0, s79, 130048
    s_add_u32 s77, s79, 12852224
    buffer_load_dwordx4 v2, s[60:63], s77 offen sc1 lds
    s_waitcnt vmcnt(21)
    s_barrier
    s_waitcnt vmcnt(14)
    s_barrier
    s_waitcnt vmcnt(8)
    s_barrier
    v_mov_b32 v2, 163616
    s_lshl_b32 s77, s75, 2
    v_add_u32 v2, s77, v2
    v_mov_b32 v3, s1
    ds_write_b32 v2, v3
    v_mov_b32 v160, 0xdddddddd
    v_and_b32 v2, 1, v1
    v_cmp_eq_u32 vcc, 0, v2
    v_mov_b32 v3, 0x3f803f80
    s_nop 0
    v_cndmask_b32 v156, 0, v3, vcc
    v_cndmask_b32 v157, 0, v3, vcc
    v_sub_u32 v158, v3, v156
    v_sub_u32 v159, v3, v156
    v_lshlrev_b32 v163, 4, v1
    s_lshl_b32 s77, s76, 14
    v_add_u32 v163, s77, v163
    s_lshl_b32 s77, s73, 7
    s_lshl_b32 s78, s75, 5
    s_add_u32 s77, s77, s78
    v_and_b32 v2, 31, v1
    v_add_u32 v2, s77, v2
    v_lshlrev_b32 v2, 11, v2
    v_lshrrev_b32 v3, 5, v1
    v_lshlrev_b32 v3, 4, v3
    v_add_u32 v164, v2, v3
    s_mov_b32 s49, 0
    s_mov_b32 s50, 0
    s_mul_i32 s44, s75, 12928
    s_add_u32 s44, s44, 0
    s_lshl_b32 s79, s2, 2
    s_add_u32 s79, s79, s75
    s_mul_i32 s52, s79, 4224
    s_lshl_b32 s77, s76, 11
    s_add_u32 s52, s52, s77
    s_add_u32 s52, s52, 4194304
    s_add_u32 s53, s44, s77
    s_mov_b32 s56, s14
    s_mov_b32 s57, s15
    s_mov_b32 s58, 0x800
    s_mov_b32 s59, 0x20000
    s_lshl_b32 s78, s79, 1
    v_mov_b32 v2, 0
    buffer_load_ushort v167, v2, s[56:59], s78 offen
    v_mov_b32 v36, 0
    v_mov_b32 v52, 0
    v_mov_b32 v37, 0
    v_mov_b32 v53, 0
    v_mov_b32 v38, 0
    v_mov_b32 v54, 0
    v_mov_b32 v39, 0
    v_mov_b32 v55, 0
    v_mov_b32 v40, 0
    v_mov_b32 v56, 0
    v_mov_b32 v41, 0
    v_mov_b32 v57, 0
    v_mov_b32 v42, 0
    v_mov_b32 v58, 0
    v_mov_b32 v43, 0
    v_mov_b32 v59, 0
    v_mov_b32 v44, 0
    v_mov_b32 v60, 0
    v_mov_b32 v45, 0
    v_mov_b32 v61, 0
    v_mov_b32 v46, 0
    v_mov_b32 v62, 0
    v_mov_b32 v47, 0
    v_mov_b32 v63, 0
    v_mov_b32 v48, 0
    v_mov_b32 v64, 0
    v_mov_b32 v49, 0
    v_mov_b32 v65, 0
    v_mov_b32 v50, 0
    v_mov_b32 v66, 0
    v_mov_b32 v51, 0
    v_mov_b32 v67, 0
    v_mov_b32 v148, 0
    v_mov_b32 v152, 0
    v_mov_b32 v149, 0
    v_mov_b32 v153, 0
    v_mov_b32 v150, 0
    v_mov_b32 v154, 0
    v_mov_b32 v151, 0
    v_mov_b32 v155, 0
    v_mov_b32 v140, 0
    v_mov_b32 v141, 0
    v_mov_b32 v142, 0
    v_mov_b32 v143, 0
    v_mov_b32 v144, 0
    v_mov_b32 v145, 0
    v_mov_b32 v146, 0
    v_mov_b32 v147, 0
    s_waitcnt vmcnt(0) lgkmcnt(0)
    s_branch MK_P1J
MK_P1C:
    v_and_b32 v2, 31, v1
    v_lshrrev_b32 v3, 1, v2
    v_and_b32 v3, 7, v3
    v_lshlrev_b32 v3, 4, v3
    s_lshl_b32 s77, s75, 5
    v_add_u32 v2, s77, v2
    v_lshlrev_b32 v2, 7, v2
    v_add_u32 v2, v2, v3
    v_lshrrev_b32 v3, 5, v1
    v_lshlrev_b32 v3, 3, v3
    v_add_u32 v19, v2, v3
    s_sub_u32 s69, s74, s68
    s_and_b32 s69, s69, 15
    v_mov_b32 v2, 163584
    v_lshlrev_b32 v3, 2, v1
    v_add_u32 v2, v2, v3
    v_mov_b32 v3, 0
    s_mov_b32 exec_lo, 0xff
    s_mov_b32 exec_hi, 0
    ds_write_b32 v2, v3
    s_mov_b64 exec, -1
    s_barrier
    s_cmp_eq_u32 s69, 0
    s_cbranch_scc0 MK_QC3
    v_xor_b32 v2, 0, v19
    ds_read_b64 v[216:217], v2 offset:0
    v_xor_b32 v2, 16, v19
    ds_read_b64 v[218:219], v2 offset:0
    v_xor_b32 v2, 32, v19
    ds_read_b64 v[220:221], v2 offset:0
    v_xor_b32 v2, 48, v19
    ds_read_b64 v[222:223], v2 offset:0
    v_xor_b32 v2, 64, v19
    ds_read_b64 v[224:225], v2 offset:0
    v_xor_b32 v2, 80, v19
    ds_read_b64 v[226:227], v2 offset:0
    v_xor_b32 v2, 96, v19
    ds_read_b64 v[228:229], v2 offset:0
    v_xor_b32 v2, 112, v19
    ds_read_b64 v[230:231], v2 offset:0
MK_QC3:
    ds_read_b128 v[52:55], v10 offset:0
    ds_read_b64_tr_b16 v[56:57], v14 offset:16384
    ds_read_b64_tr_b16 v[58:59], v14 offset:16896
    ds_read_b64_tr_b16 v[60:61], v15 offset:16384
    ds_read_b64_tr_b16 v[62:63], v15 offset:16896
    ds_read_b128 v[64:67], v11 offset:0
    ds_read_b64_tr_b16 v[68:69], v14 offset:18432
    ds_read_b64_tr_b16 v[70:71], v14 offset:18944
    ds_read_b64_tr_b16 v[72:73], v15 offset:18432
    ds_read_b64_tr_b16 v[74:75], v15 offset:18944
    ds_read_b128 v[76:79], v12 offset:0
    ds_read_b64_tr_b16 v[80:81], v14 offset:20480
    ds_read_b64_tr_b16 v[82:83], v14 offset:20992
    ds_read_b64_tr_b16 v[84:85], v15 offset:20480
    ds_read_b64_tr_b16 v[86:87], v15 offset:20992
    ds_read_b128 v[88:91], v13 offset:0
    ds_read_b64_tr_b16 v[92:93], v14 offset:22528
    ds_read_b64_tr_b16 v[94:95], v14 offset:23040
    ds_read_b64_tr_b16 v[96:97], v15 offset:22528
    ds_read_b64_tr_b16 v[98:99], v15 offset:23040
    s_waitcnt lgkmcnt(0)
    s_barrier
    s_cmp_eq_u32 s69, 1
    s_cbranch_scc0 MK_QC4
    v_xor_b32 v2, 0, v19
    ds_read_b64 v[216:217], v2 offset:24576
    v_xor_b32 v2, 16, v19
    ds_read_b64 v[218:219], v2 offset:24576
    v_xor_b32 v2, 32, v19
    ds_read_b64 v[220:221], v2 offset:24576
    v_xor_b32 v2, 48, v19
    ds_read_b64 v[222:223], v2 offset:24576
    v_xor_b32 v2, 64, v19
    ds_read_b64 v[224:225], v2 offset:24576
    v_xor_b32 v2, 80, v19
    ds_read_b64 v[226:227], v2 offset:24576
    v_xor_b32 v2, 96, v19
    ds_read_b64 v[228:229], v2 offset:24576
    v_xor_b32 v2, 112, v19
    ds_read_b64 v[230:231], v2 offset:24576
MK_QC4:
    v_mfma_f32_32x32x16_bf16 v[20:35], v[56:59], v[52:55], 0
    ds_read_b128 v[100:103], v10 offset:24576
    ds_read_b64_tr_b16 v[104:105], v14 offset:40960
    ds_read_b64_tr_b16 v[106:107], v14 offset:41472
    ds_read_b64_tr_b16 v[108:109], v15 offset:40960
    v_mfma_f32_32x32x16_bf16 v[36:51], v[60:63], v[52:55], 0
    ds_read_b64_tr_b16 v[110:111], v15 offset:41472
    ds_read_b128 v[112:115], v11 offset:24576
    ds_read_b64_tr_b16 v[116:117], v14 offset:43008
    ds_read_b64_tr_b16 v[118:119], v14 offset:43520
    v_mfma_f32_32x32x16_bf16 v[20:35], v[68:71], v[64:67], v[20:35]
    ds_read_b64_tr_b16 v[120:121], v15 offset:43008
    ds_read_b64_tr_b16 v[122:123], v15 offset:43520
    ds_read_b128 v[124:127], v12 offset:24576
    ds_read_b64_tr_b16 v[128:129], v14 offset:45056
    v_mfma_f32_32x32x16_bf16 v[36:51], v[72:75], v[64:67], v[36:51]
    ds_read_b64_tr_b16 v[130:131], v14 offset:45568
    ds_read_b64_tr_b16 v[132:133], v15 offset:45056
    ds_read_b64_tr_b16 v[134:135], v15 offset:45568
    ds_read_b128 v[136:139], v13 offset:24576
    v_mfma_f32_32x32x16_bf16 v[20:35], v[80:83], v[76:79], v[20:35]
    ds_read_b64_tr_b16 v[140:141], v14 offset:47104
    ds_read_b64_tr_b16 v[142:143], v14 offset:47616
    ds_read_b64_tr_b16 v[144:145], v15 offset:47104
    ds_read_b64_tr_b16 v[146:147], v15 offset:47616
    v_mfma_f32_32x32x16_bf16 v[36:51], v[84:87], v[76:79], v[36:51]
    v_mfma_f32_32x32x16_bf16 v[20:35], v[92:95], v[88:91], v[20:35]
    v_mfma_f32_32x32x16_bf16 v[36:51], v[96:99], v[88:91], v[36:51]
    s_waitcnt lgkmcnt(0)
    s_barrier
    s_cmp_eq_u32 s69, 2
    s_cbranch_scc0 MK_QC5
    v_xor_b32 v2, 0, v19
    ds_read_b64 v[216:217], v2 offset:49152
    v_xor_b32 v2, 16, v19
    ds_read_b64 v[218:219], v2 offset:49152
    v_xor_b32 v2, 32, v19
    ds_read_b64 v[220:221], v2 offset:49152
    v_xor_b32 v2, 48, v19
    ds_read_b64 v[222:223], v2 offset:49152
    v_xor_b32 v2, 64, v19
    ds_read_b64 v[224:225], v2 offset:49152
    v_xor_b32 v2, 80, v19
    ds_read_b64 v[226:227], v2 offset:49152
    v_xor_b32 v2, 96, v19
    ds_read_b64 v[228:229], v2 offset:49152
    v_xor_b32 v2, 112, v19
    ds_read_b64 v[230:231], v2 offset:49152
MK_QC5:
    v_mfma_f32_32x32x16_bf16 v[20:35], v[104:107], v[100:103], v[20:35]
    ds_read_b128 v[52:55], v10 offset:49152
    ds_read_b64_tr_b16 v[56:57], v212 offset:4096
    ds_read_b64_tr_b16 v[58:59], v212 offset:4608
    ds_read_b64_tr_b16 v[60:61], v213 offset:4096
    v_mfma_f32_32x32x16_bf16 v[36:51], v[108:111], v[100:103], v[36:51]
    ds_read_b64_tr_b16 v[62:63], v213 offset:4608
    ds_read_b128 v[64:67], v11 offset:49152
    ds_read_b64_tr_b16 v[68:69], v212 offset:6144
    ds_read_b64_tr_b16 v[70:71], v212 offset:6656
    v_mfma_f32_32x32x16_bf16 v[20:35], v[116:119], v[112:115], v[20:35]
    ds_read_b64_tr_b16 v[72:73], v213 offset:6144
    ds_read_b64_tr_b16 v[74:75], v213 offset:6656
    ds_read_b128 v[76:79], v12 offset:49152
    ds_read_b64_tr_b16 v[80:81], v212 offset:8192
    v_mfma_f32_32x32x16_bf16 v[36:51], v[120:123], v[112:115], v[36:51]
    ds_read_b64_tr_b16 v[82:83], v212 offset:8704
    ds_read_b64_tr_b16 v[84:85], v213 offset:8192
    ds_read_b64_tr_b16 v[86:87], v213 offset:8704
    ds_read_b128 v[88:91], v13 offset:49152
    v_mfma_f32_32x32x16_bf16 v[20:35], v[128:131], v[124:127], v[20:35]
    ds_read_b64_tr_b16 v[92:93], v212 offset:10240
    ds_read_b64_tr_b16 v[94:95], v212 offset:10752
    ds_read_b64_tr_b16 v[96:97], v213 offset:10240
    ds_read_b64_tr_b16 v[98:99], v213 offset:10752
    v_mfma_f32_32x32x16_bf16 v[36:51], v[132:135], v[124:127], v[36:51]
    v_mfma_f32_32x32x16_bf16 v[20:35], v[140:143], v[136:139], v[20:35]
    v_mfma_f32_32x32x16_bf16 v[36:51], v[144:147], v[136:139], v[36:51]
    s_waitcnt lgkmcnt(0)
    s_barrier
    s_cmp_eq_u32 s69, 3
    s_cbranch_scc0 MK_QC6
    v_xor_b32 v2, 0, v19
    v_add_u32 v2, 65536, v2
    ds_read_b64 v[216:217], v2 offset:8192
    v_xor_b32 v2, 16, v19
    v_add_u32 v2, 65536, v2
    ds_read_b64 v[218:219], v2 offset:8192
    v_xor_b32 v2, 32, v19
    v_add_u32 v2, 65536, v2
    ds_read_b64 v[220:221], v2 offset:8192
    v_xor_b32 v2, 48, v19
    v_add_u32 v2, 65536, v2
    ds_read_b64 v[222:223], v2 offset:8192
    v_xor_b32 v2, 64, v19
    v_add_u32 v2, 65536, v2
    ds_read_b64 v[224:225], v2 offset:8192
    v_xor_b32 v2, 80, v19
    v_add_u32 v2, 65536, v2
    ds_read_b64 v[226:227], v2 offset:8192
    v_xor_b32 v2, 96, v19
    v_add_u32 v2, 65536, v2
    ds_read_b64 v[228:229], v2 offset:8192
    v_xor_b32 v2, 112, v19
    v_add_u32 v2, 65536, v2
    ds_read_b64 v[230:231], v2 offset:8192
MK_QC6:
    v_mfma_f32_32x32x16_bf16 v[20:35], v[56:59], v[52:55], v[20:35]
    ds_read_b128 v[100:103], v204 offset:8192
    ds_read_b64_tr_b16 v[104:105], v212 offset:28672
    ds_read_b64_tr_b16 v[106:107], v212 offset:29184
    ds_read_b64_tr_b16 v[108:109], v213 offset:28672
    v_mfma_f32_32x32x16_bf16 v[36:51], v[60:63], v[52:55], v[36:51]
    ds_read_b64_tr_b16 v[110:111], v213 offset:29184
    ds_read_b128 v[112:115], v205 offset:8192
    ds_read_b64_tr_b16 v[116:117], v212 offset:30720
    ds_read_b64_tr_b16 v[118:119], v212 offset:31232
    v_mfma_f32_32x32x16_bf16 v[20:35], v[68:71], v[64:67], v[20:35]
    ds_read_b64_tr_b16 v[120:121], v213 offset:30720
    ds_read_b64_tr_b16 v[122:123], v213 offset:31232
    ds_read_b128 v[124:127], v206 offset:8192
    ds_read_b64_tr_b16 v[128:129], v212 offset:32768
    v_mfma_f32_32x32x16_bf16 v[36:51], v[72:75], v[64:67], v[36:51]
    ds_read_b64_tr_b16 v[130:131], v212 offset:33280
    ds_read_b64_tr_b16 v[132:133], v213 offset:32768
    ds_read_b64_tr_b16 v[134:135], v213 offset:33280
    ds_read_b128 v[136:139], v207 offset:8192
    v_mfma_f32_32x32x16_bf16 v[20:35], v[80:83], v[76:79], v[20:35]
    ds_read_b64_tr_b16 v[140:141], v212 offset:34816
    ds_read_b64_tr_b16 v[142:143], v212 offset:35328
    ds_read_b64_tr_b16 v[144:145], v213 offset:34816
    ds_read_b64_tr_b16 v[146:147], v213 offset:35328
    v_mfma_f32_32x32x16_bf16 v[36:51], v[84:87], v[76:79], v[36:51]
    v_mfma_f32_32x32x16_bf16 v[20:35], v[92:95], v[88:91], v[20:35]
    v_mfma_f32_32x32x16_bf16 v[36:51], v[96:99], v[88:91], v[36:51]
    s_waitcnt lgkmcnt(0)
    s_barrier
    s_cmp_eq_u32 s69, 4
    s_cbranch_scc0 MK_QC7
    v_xor_b32 v2, 0, v19
    v_add_u32 v2, 65536, v2
    ds_read_b64 v[216:217], v2 offset:32768
    v_xor_b32 v2, 16, v19
    v_add_u32 v2, 65536, v2
    ds_read_b64 v[218:219], v2 offset:32768
    v_xor_b32 v2, 32, v19
    v_add_u32 v2, 65536, v2
    ds_read_b64 v[220:221], v2 offset:32768
    v_xor_b32 v2, 48, v19
    v_add_u32 v2, 65536, v2
    ds_read_b64 v[222:223], v2 offset:32768
    v_xor_b32 v2, 64, v19
    v_add_u32 v2, 65536, v2
    ds_read_b64 v[224:225], v2 offset:32768
    v_xor_b32 v2, 80, v19
    v_add_u32 v2, 65536, v2
    ds_read_b64 v[226:227], v2 offset:32768
    v_xor_b32 v2, 96, v19
    v_add_u32 v2, 65536, v2
    ds_read_b64 v[228:229], v2 offset:32768
    v_xor_b32 v2, 112, v19
    v_add_u32 v2, 65536, v2
    ds_read_b64 v[230:231], v2 offset:32768
MK_QC7:
    v_mfma_f32_32x32x16_bf16 v[20:35], v[104:107], v[100:103], v[20:35]
    ds_read_b128 v[52:55], v204 offset:32768
    ds_read_b64_tr_b16 v[56:57], v212 offset:53248
    ds_read_b64_tr_b16 v[58:59], v212 offset:53760
    ds_read_b64_tr_b16 v[60:61], v213 offset:53248
    v_mfma_f32_32x32x16_bf16 v[36:51], v[108:111], v[100:103], v[36:51]
    ds_read_b64_tr_b16 v[62:63], v213 offset:53760
    ds_read_b128 v[64:67], v205 offset:32768
    ds_read_b64_tr_b16 v[68:69], v212 offset:55296
    ds_read_b64_tr_b16 v[70:71], v212 offset:55808
    v_mfma_f32_32x32x16_bf16 v[20:35], v[116:119], v[112:115], v[20:35]
    ds_read_b64_tr_b16 v[72:73], v213 offset:55296
    ds_read_b64_tr_b16 v[74:75], v213 offset:55808
    ds_read_b128 v[76:79], v206 offset:32768
    ds_read_b64_tr_b16 v[80:81], v212 offset:57344
    v_mfma_f32_32x32x16_bf16 v[36:51], v[120:123], v[112:115], v[36:51]
    ds_read_b64_tr_b16 v[82:83], v212 offset:57856
    ds_read_b64_tr_b16 v[84:85], v213 offset:57344
    ds_read_b64_tr_b16 v[86:87], v213 offset:57856
    ds_read_b128 v[88:91], v207 offset:32768
    v_mfma_f32_32x32x16_bf16 v[20:35], v[128:131], v[124:127], v[20:35]
    ds_read_b64_tr_b16 v[92:93], v212 offset:59392
    ds_read_b64_tr_b16 v[94:95], v212 offset:59904
    ds_read_b64_tr_b16 v[96:97], v213 offset:59392
    ds_read_b64_tr_b16 v[98:99], v213 offset:59904
    v_mfma_f32_32x32x16_bf16 v[36:51], v[132:135], v[124:127], v[36:51]
    v_mfma_f32_32x32x16_bf16 v[20:35], v[140:143], v[136:139], v[20:35]
    v_mfma_f32_32x32x16_bf16 v[36:51], v[144:147], v[136:139], v[36:51]
    s_waitcnt lgkmcnt(0)
    s_barrier
    s_cmp_eq_u32 s69, 5
    s_cbranch_scc0 MK_QC8
    v_xor_b32 v2, 0, v19
    ds_read_b64 v[216:217], v2 offset:0
    v_xor_b32 v2, 16, v19
    ds_read_b64 v[218:219], v2 offset:0
    v_xor_b32 v2, 32, v19
    ds_read_b64 v[220:221], v2 offset:0
    v_xor_b32 v2, 48, v19
    ds_read_b64 v[222:223], v2 offset:0
    v_xor_b32 v2, 64, v19
    ds_read_b64 v[224:225], v2 offset:0
    v_xor_b32 v2, 80, v19
    ds_read_b64 v[226:227], v2 offset:0
    v_xor_b32 v2, 96, v19
    ds_read_b64 v[228:229], v2 offset:0
    v_xor_b32 v2, 112, v19
    ds_read_b64 v[230:231], v2 offset:0
MK_QC8:
    v_mfma_f32_32x32x16_bf16 v[20:35], v[56:59], v[52:55], v[20:35]
    ds_read_b128 v[100:103], v10 offset:0
    ds_read_b64_tr_b16 v[104:105], v14 offset:16384
    ds_read_b64_tr_b16 v[106:107], v14 offset:16896
    ds_read_b64_tr_b16 v[108:109], v15 offset:16384
    v_mfma_f32_32x32x16_bf16 v[36:51], v[60:63], v[52:55], v[36:51]
    ds_read_b64_tr_b16 v[110:111], v15 offset:16896
    ds_read_b128 v[112:115], v11 offset:0
    ds_read_b64_tr_b16 v[116:117], v14 offset:18432
    ds_read_b64_tr_b16 v[118:119], v14 offset:18944
    v_mfma_f32_32x32x16_bf16 v[20:35], v[68:71], v[64:67], v[20:35]
    ds_read_b64_tr_b16 v[120:121], v15 offset:18432
    ds_read_b64_tr_b16 v[122:123], v15 offset:18944
    ds_read_b128 v[124:127], v12 offset:0
    ds_read_b64_tr_b16 v[128:129], v14 offset:20480
    v_mfma_f32_32x32x16_bf16 v[36:51], v[72:75], v[64:67], v[36:51]
    ds_read_b64_tr_b16 v[130:131], v14 offset:20992
    ds_read_b64_tr_b16 v[132:133], v15 offset:20480
    ds_read_b64_tr_b16 v[134:135], v15 offset:20992
    ds_read_b128 v[136:139], v13 offset:0
    v_mfma_f32_32x32x16_bf16 v[20:35], v[80:83], v[76:79], v[20:35]
    ds_read_b64_tr_b16 v[140:141], v14 offset:22528
    ds_read_b64_tr_b16 v[142:143], v14 offset:23040
    ds_read_b64_tr_b16 v[144:145], v15 offset:22528
    ds_read_b64_tr_b16 v[146:147], v15 offset:23040
    v_mfma_f32_32x32x16_bf16 v[36:51], v[84:87], v[76:79], v[36:51]
    v_mfma_f32_32x32x16_bf16 v[20:35], v[92:95], v[88:91], v[20:35]
    v_mfma_f32_32x32x16_bf16 v[36:51], v[96:99], v[88:91], v[36:51]
    s_waitcnt lgkmcnt(0)
    s_barrier
    s_cmp_eq_u32 s69, 6
    s_cbranch_scc0 MK_QC9
    v_xor_b32 v2, 0, v19
    ds_read_b64 v[216:217], v2 offset:24576
    v_xor_b32 v2, 16, v19
    ds_read_b64 v[218:219], v2 offset:24576
    v_xor_b32 v2, 32, v19
    ds_read_b64 v[220:221], v2 offset:24576
    v_xor_b32 v2, 48, v19
    ds_read_b64 v[222:223], v2 offset:24576
    v_xor_b32 v2, 64, v19
    ds_read_b64 v[224:225], v2 offset:24576
    v_xor_b32 v2, 80, v19
    ds_read_b64 v[226:227], v2 offset:24576
    v_xor_b32 v2, 96, v19
    ds_read_b64 v[228:229], v2 offset:24576
    v_xor_b32 v2, 112, v19
    ds_read_b64 v[230:231], v2 offset:24576
MK_QC9:
    v_mfma_f32_32x32x16_bf16 v[20:35], v[104:107], v[100:103], v[20:35]
    ds_read_b128 v[52:55], v10 offset:24576
    ds_read_b64_tr_b16 v[56:57], v14 offset:40960
    ds_read_b64_tr_b16 v[58:59], v14 offset:41472
    ds_read_b64_tr_b16 v[60:61], v15 offset:40960
    v_mfma_f32_32x32x16_bf16 v[36:51], v[108:111], v[100:103], v[36:51]
    ds_read_b64_tr_b16 v[62:63], v15 offset:41472
    ds_read_b128 v[64:67], v11 offset:24576
    ds_read_b64_tr_b16 v[68:69], v14 offset:43008
    ds_read_b64_tr_b16 v[70:71], v14 offset:43520
    v_mfma_f32_32x32x16_bf16 v[20:35], v[116:119], v[112:115], v[20:35]
    ds_read_b64_tr_b16 v[72:73], v15 offset:43008
    ds_read_b64_tr_b16 v[74:75], v15 offset:43520
    ds_read_b128 v[76:79], v12 offset:24576
    ds_read_b64_tr_b16 v[80:81], v14 offset:45056
    v_mfma_f32_32x32x16_bf16 v[36:51], v[120:123], v[112:115], v[36:51]
    ds_read_b64_tr_b16 v[82:83], v14 offset:45568
    ds_read_b64_tr_b16 v[84:85], v15 offset:45056
    ds_read_b64_tr_b16 v[86:87], v15 offset:45568
    ds_read_b128 v[88:91], v13 offset:24576
    v_mfma_f32_32x32x16_bf16 v[20:35], v[128:131], v[124:127], v[20:35]
    ds_read_b64_tr_b16 v[92:93], v14 offset:47104
    ds_read_b64_tr_b16 v[94:95], v14 offset:47616
    ds_read_b64_tr_b16 v[96:97], v15 offset:47104
    ds_read_b64_tr_b16 v[98:99], v15 offset:47616
    v_mfma_f32_32x32x16_bf16 v[36:51], v[132:135], v[124:127], v[36:51]
    v_mfma_f32_32x32x16_bf16 v[20:35], v[140:143], v[136:139], v[20:35]
    v_mfma_f32_32x32x16_bf16 v[36:51], v[144:147], v[136:139], v[36:51]
    s_waitcnt lgkmcnt(0)
    s_barrier
    s_cmp_eq_u32 s69, 7
    s_cbranch_scc0 MK_QC10
    v_xor_b32 v2, 0, v19
    ds_read_b64 v[216:217], v2 offset:49152
    v_xor_b32 v2, 16, v19
    ds_read_b64 v[218:219], v2 offset:49152
    v_xor_b32 v2, 32, v19
    ds_read_b64 v[220:221], v2 offset:49152
    v_xor_b32 v2, 48, v19
    ds_read_b64 v[222:223], v2 offset:49152
    v_xor_b32 v2, 64, v19
    ds_read_b64 v[224:225], v2 offset:49152
    v_xor_b32 v2, 80, v19
    ds_read_b64 v[226:227], v2 offset:49152
    v_xor_b32 v2, 96, v19
    ds_read_b64 v[228:229], v2 offset:49152
    v_xor_b32 v2, 112, v19
    ds_read_b64 v[230:231], v2 offset:49152
MK_QC10:
    v_mfma_f32_32x32x16_bf16 v[20:35], v[56:59], v[52:55], v[20:35]
    ds_read_b128 v[100:103], v10 offset:49152
    ds_read_b64_tr_b16 v[104:105], v212 offset:4096
    ds_read_b64_tr_b16 v[106:107], v212 offset:4608
    ds_read_b64_tr_b16 v[108:109], v213 offset:4096
    v_mfma_f32_32x32x16_bf16 v[36:51], v[60:63], v[52:55], v[36:51]
    ds_read_b64_tr_b16 v[110:111], v213 offset:4608
    ds_read_b128 v[112:115], v11 offset:49152
    ds_read_b64_tr_b16 v[116:117], v212 offset:6144
    ds_read_b64_tr_b16 v[118:119], v212 offset:6656
    v_mfma_f32_32x32x16_bf16 v[20:35], v[68:71], v[64:67], v[20:35]
    ds_read_b64_tr_b16 v[120:121], v213 offset:6144
    ds_read_b64_tr_b16 v[122:123], v213 offset:6656
    ds_read_b128 v[124:127], v12 offset:49152
    ds_read_b64_tr_b16 v[128:129], v212 offset:8192
    v_mfma_f32_32x32x16_bf16 v[36:51], v[72:75], v[64:67], v[36:51]
    ds_read_b64_tr_b16 v[130:131], v212 offset:8704
    ds_read_b64_tr_b16 v[132:133], v213 offset:8192
    ds_read_b64_tr_b16 v[134:135], v213 offset:8704
    ds_read_b128 v[136:139], v13 offset:49152
    v_mfma_f32_32x32x16_bf16 v[20:35], v[80:83], v[76:79], v[20:35]
    ds_read_b64_tr_b16 v[140:141], v212 offset:10240
    ds_read_b64_tr_b16 v[142:143], v212 offset:10752
    ds_read_b64_tr_b16 v[144:145], v213 offset:10240
    ds_read_b64_tr_b16 v[146:147], v213 offset:10752
    v_mfma_f32_32x32x16_bf16 v[36:51], v[84:87], v[76:79], v[36:51]
    v_mfma_f32_32x32x16_bf16 v[20:35], v[92:95], v[88:91], v[20:35]
    v_mfma_f32_32x32x16_bf16 v[36:51], v[96:99], v[88:91], v[36:51]
    s_waitcnt lgkmcnt(0)
    s_barrier
    s_cmp_eq_u32 s69, 8
    s_cbranch_scc0 MK_QC11
    v_xor_b32 v2, 0, v19
    v_add_u32 v2, 65536, v2
    ds_read_b64 v[216:217], v2 offset:8192
    v_xor_b32 v2, 16, v19
    v_add_u32 v2, 65536, v2
    ds_read_b64 v[218:219], v2 offset:8192
    v_xor_b32 v2, 32, v19
    v_add_u32 v2, 65536, v2
    ds_read_b64 v[220:221], v2 offset:8192
    v_xor_b32 v2, 48, v19
    v_add_u32 v2, 65536, v2
    ds_read_b64 v[222:223], v2 offset:8192
    v_xor_b32 v2, 64, v19
    v_add_u32 v2, 65536, v2
    ds_read_b64 v[224:225], v2 offset:8192
    v_xor_b32 v2, 80, v19
    v_add_u32 v2, 65536, v2
    ds_read_b64 v[226:227], v2 offset:8192
    v_xor_b32 v2, 96, v19
    v_add_u32 v2, 65536, v2
    ds_read_b64 v[228:229], v2 offset:8192
    v_xor_b32 v2, 112, v19
    v_add_u32 v2, 65536, v2
    ds_read_b64 v[230:231], v2 offset:8192
MK_QC11:
    v_mfma_f32_32x32x16_bf16 v[20:35], v[104:107], v[100:103], v[20:35]
    ds_read_b128 v[52:55], v204 offset:8192
    ds_read_b64_tr_b16 v[56:57], v212 offset:28672
    ds_read_b64_tr_b16 v[58:59], v212 offset:29184
    ds_read_b64_tr_b16 v[60:61], v213 offset:28672
    v_mfma_f32_32x32x16_bf16 v[36:51], v[108:111], v[100:103], v[36:51]
    ds_read_b64_tr_b16 v[62:63], v213 offset:29184
    ds_read_b128 v[64:67], v205 offset:8192
    ds_read_b64_tr_b16 v[68:69], v212 offset:30720
    ds_read_b64_tr_b16 v[70:71], v212 offset:31232
    v_mfma_f32_32x32x16_bf16 v[20:35], v[116:119], v[112:115], v[20:35]
    ds_read_b64_tr_b16 v[72:73], v213 offset:30720
    ds_read_b64_tr_b16 v[74:75], v213 offset:31232
    ds_read_b128 v[76:79], v206 offset:8192
    ds_read_b64_tr_b16 v[80:81], v212 offset:32768
    v_mfma_f32_32x32x16_bf16 v[36:51], v[120:123], v[112:115], v[36:51]
    ds_read_b64_tr_b16 v[82:83], v212 offset:33280
    ds_read_b64_tr_b16 v[84:85], v213 offset:32768
    ds_read_b64_tr_b16 v[86:87], v213 offset:33280
    ds_read_b128 v[88:91], v207 offset:8192
    v_mfma_f32_32x32x16_bf16 v[20:35], v[128:131], v[124:127], v[20:35]
    ds_read_b64_tr_b16 v[92:93], v212 offset:34816
    ds_read_b64_tr_b16 v[94:95], v212 offset:35328
    ds_read_b64_tr_b16 v[96:97], v213 offset:34816
    ds_read_b64_tr_b16 v[98:99], v213 offset:35328
    v_mfma_f32_32x32x16_bf16 v[36:51], v[132:135], v[124:127], v[36:51]
    v_mfma_f32_32x32x16_bf16 v[20:35], v[140:143], v[136:139], v[20:35]
    v_mfma_f32_32x32x16_bf16 v[36:51], v[144:147], v[136:139], v[36:51]
    s_waitcnt lgkmcnt(0)
    s_barrier
    s_cmp_eq_u32 s69, 9
    s_cbranch_scc0 MK_QC12
    v_xor_b32 v2, 0, v19
    v_add_u32 v2, 65536, v2
    ds_read_b64 v[216:217], v2 offset:32768
    v_xor_b32 v2, 16, v19
    v_add_u32 v2, 65536, v2
    ds_read_b64 v[218:219], v2 offset:32768
    v_xor_b32 v2, 32, v19
    v_add_u32 v2, 65536, v2
    ds_read_b64 v[220:221], v2 offset:32768
    v_xor_b32 v2, 48, v19
    v_add_u32 v2, 65536, v2
    ds_read_b64 v[222:223], v2 offset:32768
    v_xor_b32 v2, 64, v19
    v_add_u32 v2, 65536, v2
    ds_read_b64 v[224:225], v2 offset:32768
    v_xor_b32 v2, 80, v19
    v_add_u32 v2, 65536, v2
    ds_read_b64 v[226:227], v2 offset:32768
    v_xor_b32 v2, 96, v19
    v_add_u32 v2, 65536, v2
    ds_read_b64 v[228:229], v2 offset:32768
    v_xor_b32 v2, 112, v19
    v_add_u32 v2, 65536, v2
    ds_read_b64 v[230:231], v2 offset:32768
MK_QC12:
    v_mfma_f32_32x32x16_bf16 v[20:35], v[56:59], v[52:55], v[20:35]
    ds_read_b128 v[100:103], v204 offset:32768
    ds_read_b64_tr_b16 v[104:105], v212 offset:53248
    ds_read_b64_tr_b16 v[106:107], v212 offset:53760
    ds_read_b64_tr_b16 v[108:109], v213 offset:53248
    v_mfma_f32_32x32x16_bf16 v[36:51], v[60:63], v[52:55], v[36:51]
    ds_read_b64_tr_b16 v[110:111], v213 offset:53760
    ds_read_b128 v[112:115], v205 offset:32768
    ds_read_b64_tr_b16 v[116:117], v212 offset:55296
    ds_read_b64_tr_b16 v[118:119], v212 offset:55808
    v_mfma_f32_32x32x16_bf16 v[20:35], v[68:71], v[64:67], v[20:35]
    ds_read_b64_tr_b16 v[120:121], v213 offset:55296
    ds_read_b64_tr_b16 v[122:123], v213 offset:55808
    ds_read_b128 v[124:127], v206 offset:32768
    ds_read_b64_tr_b16 v[128:129], v212 offset:57344
    v_mfma_f32_32x32x16_bf16 v[36:51], v[72:75], v[64:67], v[36:51]
    ds_read_b64_tr_b16 v[130:131], v212 offset:57856
    ds_read_b64_tr_b16 v[132:133], v213 offset:57344
    ds_read_b64_tr_b16 v[134:135], v213 offset:57856
    ds_read_b128 v[136:139], v207 offset:32768
    v_mfma_f32_32x32x16_bf16 v[20:35], v[80:83], v[76:79], v[20:35]
    ds_read_b64_tr_b16 v[140:141], v212 offset:59392
    ds_read_b64_tr_b16 v[142:143], v212 offset:59904
    ds_read_b64_tr_b16 v[144:145], v213 offset:59392
    ds_read_b64_tr_b16 v[146:147], v213 offset:59904
    v_mfma_f32_32x32x16_bf16 v[36:51], v[84:87], v[76:79], v[36:51]
    v_mfma_f32_32x32x16_bf16 v[20:35], v[92:95], v[88:91], v[20:35]
    v_mfma_f32_32x32x16_bf16 v[36:51], v[96:99], v[88:91], v[36:51]
    s_waitcnt lgkmcnt(0)
    s_barrier
    s_cmp_eq_u32 s69, 10
    s_cbranch_scc0 MK_QC13
    v_xor_b32 v2, 0, v19
    ds_read_b64 v[216:217], v2 offset:0
    v_xor_b32 v2, 16, v19
    ds_read_b64 v[218:219], v2 offset:0
    v_xor_b32 v2, 32, v19
    ds_read_b64 v[220:221], v2 offset:0
    v_xor_b32 v2, 48, v19
    ds_read_b64 v[222:223], v2 offset:0
    v_xor_b32 v2, 64, v19
    ds_read_b64 v[224:225], v2 offset:0
    v_xor_b32 v2, 80, v19
    ds_read_b64 v[226:227], v2 offset:0
    v_xor_b32 v2, 96, v19
    ds_read_b64 v[228:229], v2 offset:0
    v_xor_b32 v2, 112, v19
    ds_read_b64 v[230:231], v2 offset:0
MK_QC13:
    v_mfma_f32_32x32x16_bf16 v[20:35], v[104:107], v[100:103], v[20:35]
    ds_read_b128 v[52:55], v10 offset:0
    ds_read_b64_tr_b16 v[56:57], v14 offset:16384
    ds_read_b64_tr_b16 v[58:59], v14 offset:16896
    ds_read_b64_tr_b16 v[60:61], v15 offset:16384
    v_mfma_f32_32x32x16_bf16 v[36:51], v[108:111], v[100:103], v[36:51]
    ds_read_b64_tr_b16 v[62:63], v15 offset:16896
    ds_read_b128 v[64:67], v11 offset:0
    ds_read_b64_tr_b16 v[68:69], v14 offset:18432
    ds_read_b64_tr_b16 v[70:71], v14 offset:18944
    v_mfma_f32_32x32x16_bf16 v[20:35], v[116:119], v[112:115], v[20:35]
    ds_read_b64_tr_b16 v[72:73], v15 offset:18432
    ds_read_b64_tr_b16 v[74:75], v15 offset:18944
    ds_read_b128 v[76:79], v12 offset:0
    ds_read_b64_tr_b16 v[80:81], v14 offset:20480
    v_mfma_f32_32x32x16_bf16 v[36:51], v[120:123], v[112:115], v[36:51]
    ds_read_b64_tr_b16 v[82:83], v14 offset:20992
    ds_read_b64_tr_b16 v[84:85], v15 offset:20480
    ds_read_b64_tr_b16 v[86:87], v15 offset:20992
    ds_read_b128 v[88:91], v13 offset:0
    v_mfma_f32_32x32x16_bf16 v[20:35], v[128:131], v[124:127], v[20:35]
    ds_read_b64_tr_b16 v[92:93], v14 offset:22528
    ds_read_b64_tr_b16 v[94:95], v14 offset:23040
    ds_read_b64_tr_b16 v[96:97], v15 offset:22528
    ds_read_b64_tr_b16 v[98:99], v15 offset:23040
    v_mfma_f32_32x32x16_bf16 v[36:51], v[132:135], v[124:127], v[36:51]
    v_mfma_f32_32x32x16_bf16 v[20:35], v[140:143], v[136:139], v[20:35]
    v_mfma_f32_32x32x16_bf16 v[36:51], v[144:147], v[136:139], v[36:51]
    s_waitcnt lgkmcnt(0)
    s_barrier
    s_cmp_eq_u32 s69, 11
    s_cbranch_scc0 MK_QC14
    v_xor_b32 v2, 0, v19
    ds_read_b64 v[216:217], v2 offset:24576
    v_xor_b32 v2, 16, v19
    ds_read_b64 v[218:219], v2 offset:24576
    v_xor_b32 v2, 32, v19
    ds_read_b64 v[220:221], v2 offset:24576
    v_xor_b32 v2, 48, v19
    ds_read_b64 v[222:223], v2 offset:24576
    v_xor_b32 v2, 64, v19
    ds_read_b64 v[224:225], v2 offset:24576
    v_xor_b32 v2, 80, v19
    ds_read_b64 v[226:227], v2 offset:24576
    v_xor_b32 v2, 96, v19
    ds_read_b64 v[228:229], v2 offset:24576
    v_xor_b32 v2, 112, v19
    ds_read_b64 v[230:231], v2 offset:24576
MK_QC14:
    v_mfma_f32_32x32x16_bf16 v[20:35], v[56:59], v[52:55], v[20:35]
    ds_read_b128 v[100:103], v10 offset:24576
    ds_read_b64_tr_b16 v[104:105], v14 offset:40960
    ds_read_b64_tr_b16 v[106:107], v14 offset:41472
    ds_read_b64_tr_b16 v[108:109], v15 offset:40960
    v_mfma_f32_32x32x16_bf16 v[36:51], v[60:63], v[52:55], v[36:51]
    ds_read_b64_tr_b16 v[110:111], v15 offset:41472
    ds_read_b128 v[112:115], v11 offset:24576
    ds_read_b64_tr_b16 v[116:117], v14 offset:43008
    ds_read_b64_tr_b16 v[118:119], v14 offset:43520
    v_mfma_f32_32x32x16_bf16 v[20:35], v[68:71], v[64:67], v[20:35]
    ds_read_b64_tr_b16 v[120:121], v15 offset:43008
    ds_read_b64_tr_b16 v[122:123], v15 offset:43520
    ds_read_b128 v[124:127], v12 offset:24576
    ds_read_b64_tr_b16 v[128:129], v14 offset:45056
    v_mfma_f32_32x32x16_bf16 v[36:51], v[72:75], v[64:67], v[36:51]
    ds_read_b64_tr_b16 v[130:131], v14 offset:45568
    ds_read_b64_tr_b16 v[132:133], v15 offset:45056
    ds_read_b64_tr_b16 v[134:135], v15 offset:45568
    ds_read_b128 v[136:139], v13 offset:24576
    v_mfma_f32_32x32x16_bf16 v[20:35], v[80:83], v[76:79], v[20:35]
    ds_read_b64_tr_b16 v[140:141], v14 offset:47104
    ds_read_b64_tr_b16 v[142:143], v14 offset:47616
    ds_read_b64_tr_b16 v[144:145], v15 offset:47104
    ds_read_b64_tr_b16 v[146:147], v15 offset:47616
    v_mfma_f32_32x32x16_bf16 v[36:51], v[84:87], v[76:79], v[36:51]
    v_mfma_f32_32x32x16_bf16 v[20:35], v[92:95], v[88:91], v[20:35]
    v_mfma_f32_32x32x16_bf16 v[36:51], v[96:99], v[88:91], v[36:51]
    s_waitcnt lgkmcnt(0)
    s_barrier
    s_cmp_eq_u32 s69, 12
    s_cbranch_scc0 MK_QC15
    v_xor_b32 v2, 0, v19
    ds_read_b64 v[216:217], v2 offset:49152
    v_xor_b32 v2, 16, v19
    ds_read_b64 v[218:219], v2 offset:49152
    v_xor_b32 v2, 32, v19
    ds_read_b64 v[220:221], v2 offset:49152
    v_xor_b32 v2, 48, v19
    ds_read_b64 v[222:223], v2 offset:49152
    v_xor_b32 v2, 64, v19
    ds_read_b64 v[224:225], v2 offset:49152
    v_xor_b32 v2, 80, v19
    ds_read_b64 v[226:227], v2 offset:49152
    v_xor_b32 v2, 96, v19
    ds_read_b64 v[228:229], v2 offset:49152
    v_xor_b32 v2, 112, v19
    ds_read_b64 v[230:231], v2 offset:49152
MK_QC15:
    v_mfma_f32_32x32x16_bf16 v[20:35], v[104:107], v[100:103], v[20:35]
    ds_read_b128 v[52:55], v10 offset:49152
    ds_read_b64_tr_b16 v[56:57], v212 offset:4096
    ds_read_b64_tr_b16 v[58:59], v212 offset:4608
    ds_read_b64_tr_b16 v[60:61], v213 offset:4096
    v_mfma_f32_32x32x16_bf16 v[36:51], v[108:111], v[100:103], v[36:51]
    ds_read_b64_tr_b16 v[62:63], v213 offset:4608
    ds_read_b128 v[64:67], v11 offset:49152
    ds_read_b64_tr_b16 v[68:69], v212 offset:6144
    ds_read_b64_tr_b16 v[70:71], v212 offset:6656
    v_mfma_f32_32x32x16_bf16 v[20:35], v[116:119], v[112:115], v[20:35]
    ds_read_b64_tr_b16 v[72:73], v213 offset:6144
    ds_read_b64_tr_b16 v[74:75], v213 offset:6656
    ds_read_b128 v[76:79], v12 offset:49152
    ds_read_b64_tr_b16 v[80:81], v212 offset:8192
    v_mfma_f32_32x32x16_bf16 v[36:51], v[120:123], v[112:115], v[36:51]
    ds_read_b64_tr_b16 v[82:83], v212 offset:8704
    ds_read_b64_tr_b16 v[84:85], v213 offset:8192
    ds_read_b64_tr_b16 v[86:87], v213 offset:8704
    ds_read_b128 v[88:91], v13 offset:49152
    v_mfma_f32_32x32x16_bf16 v[20:35], v[128:131], v[124:127], v[20:35]
    ds_read_b64_tr_b16 v[92:93], v212 offset:10240
    ds_read_b64_tr_b16 v[94:95], v212 offset:10752
    ds_read_b64_tr_b16 v[96:97], v213 offset:10240
    ds_read_b64_tr_b16 v[98:99], v213 offset:10752
    v_mfma_f32_32x32x16_bf16 v[36:51], v[132:135], v[124:127], v[36:51]
    v_mfma_f32_32x32x16_bf16 v[20:35], v[140:143], v[136:139], v[20:35]
    v_mfma_f32_32x32x16_bf16 v[36:51], v[144:147], v[136:139], v[36:51]
    s_waitcnt lgkmcnt(0)
    s_barrier
    s_cmp_eq_u32 s69, 13
    s_cbranch_scc0 MK_QC16
    v_xor_b32 v2, 0, v19
    v_add_u32 v2, 65536, v2
    ds_read_b64 v[216:217], v2 offset:8192
    v_xor_b32 v2, 16, v19
    v_add_u32 v2, 65536, v2
    ds_read_b64 v[218:219], v2 offset:8192
    v_xor_b32 v2, 32, v19
    v_add_u32 v2, 65536, v2
    ds_read_b64 v[220:221], v2 offset:8192
    v_xor_b32 v2, 48, v19
    v_add_u32 v2, 65536, v2
    ds_read_b64 v[222:223], v2 offset:8192
    v_xor_b32 v2, 64, v19
    v_add_u32 v2, 65536, v2
    ds_read_b64 v[224:225], v2 offset:8192
    v_xor_b32 v2, 80, v19
    v_add_u32 v2, 65536, v2
    ds_read_b64 v[226:227], v2 offset:8192
    v_xor_b32 v2, 96, v19
    v_add_u32 v2, 65536, v2
    ds_read_b64 v[228:229], v2 offset:8192
    v_xor_b32 v2, 112, v19
    v_add_u32 v2, 65536, v2
    ds_read_b64 v[230:231], v2 offset:8192
MK_QC16:
    v_mfma_f32_32x32x16_bf16 v[20:35], v[56:59], v[52:55], v[20:35]
    ds_read_b128 v[100:103], v204 offset:8192
    ds_read_b64_tr_b16 v[104:105], v212 offset:28672
    ds_read_b64_tr_b16 v[106:107], v212 offset:29184
    ds_read_b64_tr_b16 v[108:109], v213 offset:28672
    v_mfma_f32_32x32x16_bf16 v[36:51], v[60:63], v[52:55], v[36:51]
    ds_read_b64_tr_b16 v[110:111], v213 offset:29184
    ds_read_b128 v[112:115], v205 offset:8192
    ds_read_b64_tr_b16 v[116:117], v212 offset:30720
    ds_read_b64_tr_b16 v[118:119], v212 offset:31232
    v_mfma_f32_32x32x16_bf16 v[20:35], v[68:71], v[64:67], v[20:35]
    ds_read_b64_tr_b16 v[120:121], v213 offset:30720
    ds_read_b64_tr_b16 v[122:123], v213 offset:31232
    ds_read_b128 v[124:127], v206 offset:8192
    ds_read_b64_tr_b16 v[128:129], v212 offset:32768
    v_mfma_f32_32x32x16_bf16 v[36:51], v[72:75], v[64:67], v[36:51]
    ds_read_b64_tr_b16 v[130:131], v212 offset:33280
    ds_read_b64_tr_b16 v[132:133], v213 offset:32768
    ds_read_b64_tr_b16 v[134:135], v213 offset:33280
    ds_read_b128 v[136:139], v207 offset:8192
    v_mfma_f32_32x32x16_bf16 v[20:35], v[80:83], v[76:79], v[20:35]
    ds_read_b64_tr_b16 v[140:141], v212 offset:34816
    ds_read_b64_tr_b16 v[142:143], v212 offset:35328
    ds_read_b64_tr_b16 v[144:145], v213 offset:34816
    ds_read_b64_tr_b16 v[146:147], v213 offset:35328
    v_mfma_f32_32x32x16_bf16 v[36:51], v[84:87], v[76:79], v[36:51]
    v_mfma_f32_32x32x16_bf16 v[20:35], v[92:95], v[88:91], v[20:35]
    v_mfma_f32_32x32x16_bf16 v[36:51], v[96:99], v[88:91], v[36:51]
    s_waitcnt lgkmcnt(0)
    s_barrier
    s_cmp_eq_u32 s69, 14
    s_cbranch_scc0 MK_QC17
    v_xor_b32 v2, 0, v19
    v_add_u32 v2, 65536, v2
    ds_read_b64 v[216:217], v2 offset:32768
    v_xor_b32 v2, 16, v19
    v_add_u32 v2, 65536, v2
    ds_read_b64 v[218:219], v2 offset:32768
    v_xor_b32 v2, 32, v19
    v_add_u32 v2, 65536, v2
    ds_read_b64 v[220:221], v2 offset:32768
    v_xor_b32 v2, 48, v19
    v_add_u32 v2, 65536, v2
    ds_read_b64 v[222:223], v2 offset:32768
    v_xor_b32 v2, 64, v19
    v_add_u32 v2, 65536, v2
    ds_read_b64 v[224:225], v2 offset:32768
    v_xor_b32 v2, 80, v19
    v_add_u32 v2, 65536, v2
    ds_read_b64 v[226:227], v2 offset:32768
    v_xor_b32 v2, 96, v19
    v_add_u32 v2, 65536, v2
    ds_read_b64 v[228:229], v2 offset:32768
    v_xor_b32 v2, 112, v19
    v_add_u32 v2, 65536, v2
    ds_read_b64 v[230:231], v2 offset:32768
MK_QC17:
    v_mfma_f32_32x32x16_bf16 v[20:35], v[104:107], v[100:103], v[20:35]
    ds_read_b128 v[52:55], v204 offset:32768
    ds_read_b64_tr_b16 v[56:57], v212 offset:53248
    ds_read_b64_tr_b16 v[58:59], v212 offset:53760
    ds_read_b64_tr_b16 v[60:61], v213 offset:53248
    v_mfma_f32_32x32x16_bf16 v[36:51], v[108:111], v[100:103], v[36:51]
    ds_read_b64_tr_b16 v[62:63], v213 offset:53760
    ds_read_b128 v[64:67], v205 offset:32768
    ds_read_b64_tr_b16 v[68:69], v212 offset:55296
    ds_read_b64_tr_b16 v[70:71], v212 offset:55808
    v_mfma_f32_32x32x16_bf16 v[20:35], v[116:119], v[112:115], v[20:35]
    ds_read_b64_tr_b16 v[72:73], v213 offset:55296
    ds_read_b64_tr_b16 v[74:75], v213 offset:55808
    ds_read_b128 v[76:79], v206 offset:32768
    ds_read_b64_tr_b16 v[80:81], v212 offset:57344
    v_mfma_f32_32x32x16_bf16 v[36:51], v[120:123], v[112:115], v[36:51]
    ds_read_b64_tr_b16 v[82:83], v212 offset:57856
    ds_read_b64_tr_b16 v[84:85], v213 offset:57344
    ds_read_b64_tr_b16 v[86:87], v213 offset:57856
    ds_read_b128 v[88:91], v207 offset:32768
    v_mfma_f32_32x32x16_bf16 v[20:35], v[128:131], v[124:127], v[20:35]
    ds_read_b64_tr_b16 v[92:93], v212 offset:59392
    ds_read_b64_tr_b16 v[94:95], v212 offset:59904
    ds_read_b64_tr_b16 v[96:97], v213 offset:59392
    ds_read_b64_tr_b16 v[98:99], v213 offset:59904
    v_mfma_f32_32x32x16_bf16 v[36:51], v[132:135], v[124:127], v[36:51]
    v_mfma_f32_32x32x16_bf16 v[20:35], v[140:143], v[136:139], v[20:35]
    v_mfma_f32_32x32x16_bf16 v[36:51], v[144:147], v[136:139], v[36:51]
    s_waitcnt lgkmcnt(0)
    s_barrier
    s_cmp_eq_u32 s69, 15
    s_cbranch_scc0 MK_QC18
    v_xor_b32 v2, 0, v19
    ds_read_b64 v[216:217], v2 offset:0
    v_xor_b32 v2, 16, v19
    ds_read_b64 v[218:219], v2 offset:0
    v_xor_b32 v2, 32, v19
    ds_read_b64 v[220:221], v2 offset:0
    v_xor_b32 v2, 48, v19
    ds_read_b64 v[222:223], v2 offset:0
    v_xor_b32 v2, 64, v19
    ds_read_b64 v[224:225], v2 offset:0
    v_xor_b32 v2, 80, v19
    ds_read_b64 v[226:227], v2 offset:0
    v_xor_b32 v2, 96, v19
    ds_read_b64 v[228:229], v2 offset:0
    v_xor_b32 v2, 112, v19
    ds_read_b64 v[230:231], v2 offset:0
MK_QC18:
    v_mfma_f32_32x32x16_bf16 v[20:35], v[56:59], v[52:55], v[20:35]
    ds_read_b128 v[100:103], v10 offset:0
    ds_read_b64_tr_b16 v[104:105], v14 offset:16384
    ds_read_b64_tr_b16 v[106:107], v14 offset:16896
    ds_read_b64_tr_b16 v[108:109], v15 offset:16384
    v_mfma_f32_32x32x16_bf16 v[36:51], v[60:63], v[52:55], v[36:51]
    ds_read_b64_tr_b16 v[110:111], v15 offset:16896
    ds_read_b128 v[112:115], v11 offset:0
    ds_read_b64_tr_b16 v[116:117], v14 offset:18432
    ds_read_b64_tr_b16 v[118:119], v14 offset:18944
    v_mfma_f32_32x32x16_bf16 v[20:35], v[68:71], v[64:67], v[20:35]
    ds_read_b64_tr_b16 v[120:121], v15 offset:18432
    ds_read_b64_tr_b16 v[122:123], v15 offset:18944
    ds_read_b128 v[124:127], v12 offset:0
    ds_read_b64_tr_b16 v[128:129], v14 offset:20480
    v_mfma_f32_32x32x16_bf16 v[36:51], v[72:75], v[64:67], v[36:51]
    ds_read_b64_tr_b16 v[130:131], v14 offset:20992
    ds_read_b64_tr_b16 v[132:133], v15 offset:20480
    ds_read_b64_tr_b16 v[134:135], v15 offset:20992
    ds_read_b128 v[136:139], v13 offset:0
    v_mfma_f32_32x32x16_bf16 v[20:35], v[80:83], v[76:79], v[20:35]
    ds_read_b64_tr_b16 v[140:141], v14 offset:22528
    ds_read_b64_tr_b16 v[142:143], v14 offset:23040
    ds_read_b64_tr_b16 v[144:145], v15 offset:22528
    ds_read_b64_tr_b16 v[146:147], v15 offset:23040
    v_mfma_f32_32x32x16_bf16 v[36:51], v[84:87], v[76:79], v[36:51]
    v_mfma_f32_32x32x16_bf16 v[20:35], v[92:95], v[88:91], v[20:35]
    v_mfma_f32_32x32x16_bf16 v[36:51], v[96:99], v[88:91], v[36:51]
    s_waitcnt lgkmcnt(0)
    v_mfma_f32_32x32x16_bf16 v[20:35], v[104:107], v[100:103], v[20:35]
    v_mfma_f32_32x32x16_bf16 v[36:51], v[108:111], v[100:103], v[36:51]
    v_mfma_f32_32x32x16_bf16 v[20:35], v[116:119], v[112:115], v[20:35]
    v_mfma_f32_32x32x16_bf16 v[36:51], v[120:123], v[112:115], v[36:51]
    v_mfma_f32_32x32x16_bf16 v[20:35], v[128:131], v[124:127], v[20:35]
    v_mfma_f32_32x32x16_bf16 v[36:51], v[132:135], v[124:127], v[36:51]
    v_mfma_f32_32x32x16_bf16 v[20:35], v[140:143], v[136:139], v[20:35]
    v_mfma_f32_32x32x16_bf16 v[36:51], v[144:147], v[136:139], v[36:51]
    s_nop 7
    s_nop 3
    s_mov_b32 s78, 0x3e8293ee
    v_mul_f32 v20, s78, v20
    v_mul_f32 v21, s78, v21
    v_mul_f32 v22, s78, v22
    v_mul_f32 v23, s78, v23
    v_mul_f32 v24, s78, v24
    v_mul_f32 v25, s78, v25
    v_mul_f32 v26, s78, v26
    v_mul_f32 v27, s78, v27
    v_mul_f32 v28, s78, v28
    v_mul_f32 v29, s78, v29
    v_mul_f32 v30, s78, v30
    v_mul_f32 v31, s78, v31
    v_mul_f32 v32, s78, v32
    v_mul_f32 v33, s78, v33
    v_mul_f32 v34, s78, v34
    v_mul_f32 v35, s78, v35
    v_mul_f32 v36, s78, v36
    v_mul_f32 v37, s78, v37
    v_mul_f32 v38, s78, v38
    v_mul_f32 v39, s78, v39
    v_mul_f32 v40, s78, v40
    v_mul_f32 v41, s78, v41
    v_mul_f32 v42, s78, v42
    v_mul_f32 v43, s78, v43
    v_mul_f32 v44, s78, v44
    v_mul_f32 v45, s78, v45
    v_mul_f32 v46, s78, v46
    v_mul_f32 v47, s78, v47
    v_mul_f32 v48, s78, v48
    v_mul_f32 v49, s78, v49
    v_mul_f32 v50, s78, v50
    v_mul_f32 v51, s78, v51
    v_cvt_pk_bf16_f32 v240, v20, v21
    v_cvt_pk_bf16_f32 v241, v22, v23
    v_cvt_pk_bf16_f32 v242, v24, v25
    v_cvt_pk_bf16_f32 v243, v26, v27
    v_cvt_pk_bf16_f32 v244, v28, v29
    v_cvt_pk_bf16_f32 v245, v30, v31
    v_cvt_pk_bf16_f32 v246, v32, v33
    v_cvt_pk_bf16_f32 v247, v34, v35
    v_cvt_pk_bf16_f32 v248, v36, v37
    v_cvt_pk_bf16_f32 v249, v38, v39
    v_cvt_pk_bf16_f32 v250, v40, v41
    v_cvt_pk_bf16_f32 v251, v42, v43
    v_cvt_pk_bf16_f32 v252, v44, v45
    v_cvt_pk_bf16_f32 v253, v46, v47
    v_cvt_pk_bf16_f32 v254, v48, v49
    v_cvt_pk_bf16_f32 v255, v50, v51
    v_mov_b32 v160, 0xdddddddd
    v_and_b32 v2, 1, v1
    v_cmp_eq_u32 vcc, 0, v2
    v_mov_b32 v3, 0x3f803f80
    s_nop 0
    v_cndmask_b32 v156, 0, v3, vcc
    v_cndmask_b32 v157, 0, v3, vcc
    v_sub_u32 v158, v3, v156
    v_sub_u32 v159, v3, v156
    v_lshlrev_b32 v163, 4, v1
    s_lshl_b32 s77, s76, 14
    v_add_u32 v163, s77, v163
    s_lshl_b32 s77, s73, 7
    s_lshl_b32 s78, s75, 5
    s_add_u32 s77, s77, s78
    v_and_b32 v2, 31, v1
    v_add_u32 v2, s77, v2
    v_lshlrev_b32 v2, 11, v2
    v_lshrrev_b32 v3, 5, v1
    v_lshlrev_b32 v3, 4, v3
    v_add_u32 v164, v2, v3
    s_mov_b32 s49, 0
    s_mov_b32 s50, 0
    s_mul_i32 s44, s75, 12928
    s_add_u32 s44, s44, 0
    s_lshl_b32 s79, s2, 2
    s_add_u32 s79, s79, s75
    s_mul_i32 s52, s79, 4224
    s_lshl_b32 s77, s76, 11
    s_add_u32 s52, s52, s77
    s_add_u32 s52, s52, 4194304
    s_add_u32 s53, s44, s77
    s_mov_b32 s56, s14
    s_mov_b32 s57, s15
    s_mov_b32 s58, 0x800
    s_mov_b32 s59, 0x20000
    s_lshl_b32 s78, s79, 1
    v_mov_b32 v2, 0
    buffer_load_ushort v167, v2, s[56:59], s78 offen
    v_mov_b32 v36, 0
    v_mov_b32 v52, 0
    v_mov_b32 v37, 0
    v_mov_b32 v53, 0
    v_mov_b32 v38, 0
    v_mov_b32 v54, 0
    v_mov_b32 v39, 0
    v_mov_b32 v55, 0
    v_mov_b32 v40, 0
    v_mov_b32 v56, 0
    v_mov_b32 v41, 0
    v_mov_b32 v57, 0
    v_mov_b32 v42, 0
    v_mov_b32 v58, 0
    v_mov_b32 v43, 0
    v_mov_b32 v59, 0
    v_mov_b32 v44, 0
    v_mov_b32 v60, 0
    v_mov_b32 v45, 0
    v_mov_b32 v61, 0
    v_mov_b32 v46, 0
    v_mov_b32 v62, 0
    v_mov_b32 v47, 0
    v_mov_b32 v63, 0
    v_mov_b32 v48, 0
    v_mov_b32 v64, 0
    v_mov_b32 v49, 0
    v_mov_b32 v65, 0
    v_mov_b32 v50, 0
    v_mov_b32 v66, 0
    v_mov_b32 v51, 0
    v_mov_b32 v67, 0
    v_mov_b32 v148, 0
    v_mov_b32 v152, 0
    v_mov_b32 v149, 0
    v_mov_b32 v153, 0
    v_mov_b32 v150, 0
    v_mov_b32 v154, 0
    v_mov_b32 v151, 0
    v_mov_b32 v155, 0
    v_mov_b32 v140, 0
    v_mov_b32 v141, 0
    v_mov_b32 v142, 0
    v_mov_b32 v143, 0
    v_mov_b32 v144, 0
    v_mov_b32 v145, 0
    v_mov_b32 v146, 0
    v_mov_b32 v147, 0
MK_P1J:
    s_barrier
    v_lshlrev_b32 v9, 4, v1
    s_cmp_ge_u32 s72, 4
    s_cbranch_scc1 MK_E1W
    s_lshl_b32 s77, s75, 12
    v_add_u32 v2, s77, v9
    ds_write_b128 v2, v[240:243] offset:0
    ds_write_b128 v2, v[244:247] offset:1024
    ds_write_b128 v2, v[248:251] offset:2048
    ds_write_b128 v2, v[252:255] offset:3072
MK_E1W:
    s_mov_b32 s64, s12
    s_mov_b32 s65, s13
    s_mov_b32 s66, 0x400000
    s_mov_b32 s67, 0x20000
    v_lshlrev_b32 v166, 4, v1
    s_lshl_b32 s51, s72, 12
    s_waitcnt lgkmcnt(0)
    s_barrier
    s_cmp_ge_u32 s72, 4
    s_cbranch_scc0 MK_NOQ
    s_lshl_b32 s77, s75, 12
    v_add_u32 v2, s77, v166
    ds_read_b128 v[240:243], v2 offset:0
    ds_read_b128 v[244:247], v2 offset:1024
    ds_read_b128 v[248:251], v2 offset:2048
    ds_read_b128 v[252:255], v2 offset:3072
MK_NOQ:
    v_mov_b32 v2, 163616
    ds_read_b128 v[168:171], v2
    s_waitcnt lgkmcnt(0)
    v_and_b32 v168, v168, v169
    v_and_b32 v170, v170, v171
    v_and_b32 v168, v168, v170
    s_nop 0
    v_readfirstlane_b32 s77, v168
    s_nop 3
    s_cmp_eq_u32 s77, 1
    s_cbranch_scc1 MK_C0OK
    s_mov_b32 s54, 13176832
    v_lshlrev_b32 v177, 8, v1
    s_mov_b32 exec_lo, 0xff
    s_mov_b32 exec_hi, 0
    s_mov_b32 s78, 0x20000
MK_POLL19:
    buffer_load_dword v178, v177, s[60:63], s54 offen sc1
    s_waitcnt vmcnt(0)
    v_cmp_gt_u32 vcc, 32, v178
    s_cbranch_vccz MK_POLL19D
    s_sleep 1
    s_sub_u32 s78, s78, 1
    s_cmp_lg_u32 s78, 0
    s_cbranch_scc1 MK_POLL19
MK_POLL19D:
    s_mov_b64 exec, -1
    s_add_u32 s45, s51, 12845056
    s_add_u32 s46, s51, 122880
    s_add_u32 m0, s46, 0
    s_add_u32 s78, s45, 0
    buffer_load_dwordx4 v166, s[60:63], s78 offen sc1 lds
    s_add_u32 m0, s46, 1024
    s_add_u32 s78, s45, 1024
    buffer_load_dwordx4 v166, s[60:63], s78 offen sc1 lds
    s_add_u32 m0, s46, 2048
    s_add_u32 s78, s45, 2048
    buffer_load_dwordx4 v166, s[60:63], s78 offen sc1 lds
    s_add_u32 m0, s46, 3072
    s_add_u32 s78, s45, 3072
    buffer_load_dwordx4 v166, s[60:63], s78 offen sc1 lds
    s_waitcnt vmcnt(0)
MK_C0OK:
    s_add_u32 s45, s51, 12877824
    s_add_u32 s46, s51, 53248
    s_add_u32 m0, s46, 0
    s_add_u32 s78, s45, 0
    buffer_load_dwordx4 v166, s[60:63], s78 offen sc1 lds
    s_add_u32 m0, s46, 1024
    s_add_u32 s78, s45, 1024
    buffer_load_dwordx4 v166, s[60:63], s78 offen sc1 lds
    s_add_u32 m0, s46, 2048
    s_add_u32 s78, s45, 2048
    buffer_load_dwordx4 v166, s[60:63], s78 offen sc1 lds
    s_add_u32 m0, s46, 3072
    s_add_u32 s78, s45, 3072
    buffer_load_dwordx4 v166, s[60:63], s78 offen sc1 lds
    v_mov_b32 v2, 51712
    v_mov_b32 v3, 0
    ds_write_b32 v2, v3
    s_mov_b32 s56, s10
    s_mov_b32 s57, s11
    s_mov_b32 s58, 0x2000
    s_mov_b32 s59, 0x20000
    v_and_b32 v206, 31, v1
    v_lshlrev_b32 v206, 4, v206
    s_lshl_b32 s77, s74, 9
    buffer_load_dwordx4 v[232:235], v206, s[56:59], s77 offen
    v_lshrrev_b32 v2, 5, v1
    s_lshl_b32 s77, s72, 1
    v_add_u32 v2, s77, v2
    v_lshlrev_b32 v2, 10, v2
    v_and_b32 v3, 31, v1
    v_lshlrev_b32 v3, 2, v3
    v_add_u32 v239, v2, v3
    s_mov_b32 s32, s6
    s_mov_b32 s33, s7
    s_mov_b32 s34, 0x400000
    s_mov_b32 s35, 0x20000
    s_mov_b32 s36, s8
    s_mov_b32 s37, s9
    s_mov_b32 s38, 0x400000
    s_mov_b32 s39, 0x20000
    s_waitcnt lgkmcnt(0)
    s_barrier
    v_add_u32 v161, 122880, v163
    ds_read_b128 v[116:119], v161
    ds_read_b128 v[120:123], v161 offset:1024
    s_waitcnt lgkmcnt(0)
    v_mfma_f32_32x32x16_bf16 v[4:19], v[116:119], v[240:243], 0
    v_mfma_f32_32x32x16_bf16 v[20:35], v[116:119], v[248:251], 0
    v_mfma_f32_32x32x16_bf16 v[4:19], v[120:123], v[244:247], v[4:19]
    v_mfma_f32_32x32x16_bf16 v[20:35], v[120:123], v[252:255], v[20:35]
    s_nop 7
    s_nop 7
    v_max3_f32 v68, v4, v5, v6
    v_max3_f32 v68, v68, v7, v8
    v_max3_f32 v68, v68, v9, v10
    v_max3_f32 v68, v68, v11, v12
    v_max3_f32 v68, v68, v13, v14
    v_max3_f32 v68, v68, v15, v16
    v_max3_f32 v68, v68, v17, v18
    v_max_f32 v68, v68, v19
    v_max3_f32 v84, v20, v21, v22
    v_max3_f32 v84, v84, v23, v24
    v_max3_f32 v84, v84, v25, v26
    v_max3_f32 v84, v84, v27, v28
    v_max3_f32 v84, v84, v29, v30
    v_max3_f32 v84, v84, v31, v32
    v_max3_f32 v84, v84, v33, v34
    v_max_f32 v84, v84, v35
    v_mov_b32 v2, v68
    s_nop 1
    v_permlane32_swap_b32 v2, v68
    s_nop 1
    v_max_f32 v68, v68, v2
    v_mov_b32 v2, v84
    s_nop 1
    v_permlane32_swap_b32 v2, v84
    s_nop 1
    v_max_f32 v84, v84, v2
    v_sub_f32 v68, 0, v68
    v_mov_b32 v69, v68
    v_mov_b32 v70, v68
    v_mov_b32 v71, v68
    v_mov_b32 v72, v68
    v_mov_b32 v73, v68
    v_mov_b32 v74, v68
    v_mov_b32 v75, v68
    v_mov_b32 v76, v68
    v_mov_b32 v77, v68
    v_mov_b32 v78, v68
    v_mov_b32 v79, v68
    v_mov_b32 v80, v68
    v_mov_b32 v81, v68
    v_mov_b32 v82, v68
    v_mov_b32 v83, v68
    v_sub_f32 v84, 0, v84
    v_mov_b32 v85, v84
    v_mov_b32 v86, v84
    v_mov_b32 v87, v84
    v_mov_b32 v88, v84
    v_mov_b32 v89, v84
    v_mov_b32 v90, v84
    v_mov_b32 v91, v84
    v_mov_b32 v92, v84
    v_mov_b32 v93, v84
    v_mov_b32 v94, v84
    v_mov_b32 v95, v84
    v_mov_b32 v96, v84
    v_mov_b32 v97, v84
    v_mov_b32 v98, v84
    v_mov_b32 v99, v84
MK_ATT:
    s_cmp_eq_u32 s49, 0
    s_cselect_b32 s40, 237, 0
    s_cselect_b32 s41, 4, 0
    s_cselect_b32 s42, 9, 0
    s_or_b32 s77, s49, s72
    s_cmp_eq_u32 s77, 0
    s_cselect_b32 s98, 4, 99
    v_mov_b32 v20, 0
    v_mov_b32 v21, 0
    v_mov_b32 v22, 0
    v_mov_b32 v23, 0
    v_mov_b32 v24, 0
    v_mov_b32 v25, 0
    v_mov_b32 v26, 0
    v_mov_b32 v27, 0
    v_mov_b32 v28, 0
    v_mov_b32 v29, 0
    v_mov_b32 v30, 0
    v_mov_b32 v31, 0
    v_mov_b32 v32, 0
    v_mov_b32 v33, 0
    v_mov_b32 v34, 0
    v_mov_b32 v35, 0
    v_add_u32 v161, 122880, v163
    v_add_u32 v162, 53248, v163
    s_mov_b32 s47, 0
    s_mov_b32 s43, 122880
    s_mov_b32 s54, 53248
    s_mov_b32 s55, 86016
    s_add_u32 s45, s51, 12877824
    s_mov_b32 s48, 0
    v_mfma_f32_32x32x16_bf16 v[4:19], v[116:119], v[240:243], v[68:83]
    v_mfma_f32_32x32x16_bf16 v[4:19], v[120:123], v[244:247], v[4:19]
    s_nop 7
    s_nop 7
    .p2align 6
MK_LOOP:
    ds_read_b128 v[132:135], v161 offset:2048
    ds_read_b128 v[136:139], v161 offset:3072
    ds_read_b128 v[124:127], v161 offset:4096
    ds_read_b128 v[128:131], v161 offset:5120
    s_setprio 2
    v_smfmac_f32_32x32x32_bf16 v[52:67], v[140:143], v[20:27], v160
    v_exp_f32 v4, v4
    v_exp_f32 v5, v5
    v_exp_f32 v6, v6
    v_smfmac_f32_32x32x32_bf16 v[52:67], v[144:147], v[28:35], v160
    v_exp_f32 v7, v7
    v_exp_f32 v8, v8
    v_exp_f32 v9, v9
    v_smfmac_f32_16x16x64_bf16 v[152:155], v[156:159], v[20:27], v160
    v_exp_f32 v10, v10
    v_smfmac_f32_16x16x64_bf16 v[152:155], v[156:159], v[28:35], v160
    v_exp_f32 v11, v11
    s_cmp_eq_u32 s48, 0
    s_cbranch_scc1 MK_DP20
    s_add_u32 m0, s46, 2048
    s_add_u32 s78, s45, 2048
    buffer_load_dwordx4 v166, s[60:63], s78 offen sc1 lds
MK_DP20:
    v_mfma_f32_32x32x16_bf16 v[20:35], v[116:119], v[248:251], v[84:99]
    v_exp_f32 v12, v12
    v_exp_f32 v13, v13
    v_exp_f32 v14, v14
    v_mfma_f32_32x32x16_bf16 v[20:35], v[120:123], v[252:255], v[20:35]
    v_exp_f32 v15, v15
    v_exp_f32 v16, v16
    v_exp_f32 v17, v17
    v_exp_f32 v18, v18
    v_exp_f32 v19, v19
    s_waitcnt lgkmcnt(2)
    v_smfmac_f32_32x32x32_bf16 v[36:51], v[132:135], v[4:11], v160
    v_exp_f32 v20, v20
    v_exp_f32 v21, v21
    v_exp_f32 v22, v22
    v_smfmac_f32_32x32x32_bf16 v[36:51], v[136:139], v[12:19], v160
    v_exp_f32 v23, v23
    v_exp_f32 v24, v24
    v_exp_f32 v25, v25
    v_smfmac_f32_16x16x64_bf16 v[148:151], v[156:159], v[4:11], v160
    v_exp_f32 v26, v26
    v_smfmac_f32_16x16x64_bf16 v[148:151], v[156:159], v[12:19], v160
    v_exp_f32 v27, v27
    s_cmp_eq_u32 s48, 0
    s_cbranch_scc1 MK_DP21
    s_add_u32 m0, s46, 3072
    s_add_u32 s78, s45, 3072
    buffer_load_dwordx4 v166, s[60:63], s78 offen sc1 lds
MK_DP21:
    s_waitcnt lgkmcnt(0)
    v_mfma_f32_32x32x16_bf16 v[4:19], v[124:127], v[240:243], v[68:83]
    v_exp_f32 v28, v28
    v_exp_f32 v29, v29
    v_exp_f32 v30, v30
    v_mfma_f32_32x32x16_bf16 v[4:19], v[128:131], v[244:247], v[4:19]
    v_exp_f32 v31, v31
    v_exp_f32 v32, v32
    v_exp_f32 v33, v33
    v_exp_f32 v34, v34
    v_exp_f32 v35, v35
    ds_read_b128 v[140:143], v161 offset:6144
    ds_read_b128 v[144:147], v161 offset:7168
    ds_read_b128 v[116:119], v161 offset:8192
    ds_read_b128 v[120:123], v161 offset:9216
    s_setprio 1
    v_smfmac_f32_32x32x32_bf16 v[52:67], v[132:135], v[20:27], v160
    v_exp_f32 v4, v4
    v_exp_f32 v5, v5
    v_exp_f32 v6, v6
    v_smfmac_f32_32x32x32_bf16 v[52:67], v[136:139], v[28:35], v160
    v_exp_f32 v7, v7
    v_exp_f32 v8, v8
    v_exp_f32 v9, v9
    v_smfmac_f32_16x16x64_bf16 v[152:155], v[156:159], v[20:27], v160
    v_exp_f32 v10, v10
    v_smfmac_f32_16x16x64_bf16 v[152:155], v[156:159], v[28:35], v160
    v_exp_f32 v11, v11
    s_bitcmp1_b32 s40, s47
    s_cbranch_scc0 MK_L1D
    s_cmp_eq_u32 s47, 0
    s_cbranch_scc0 MK_L1A
    s_lshl_b32 s77, s73, 7
    s_lshl_b32 s78, s72, 4
    s_add_u32 s77, s77, s78
    v_lshrrev_b32 v177, 3, v1
    v_add_u32 v177, s77, v177
    v_lshlrev_b32 v177, 11, v177
    v_and_b32 v178, 7, v1
    v_lshlrev_b32 v178, 4, v178
    v_add_u32 v177, v177, v178
    s_lshl_b32 s77, s74, 7
    v_add_u32 v177, s77, v177
    s_cmp_eq_u32 s72, 0
    s_cbranch_scc0 MK_L1H
    v_subrev_u32 v178, 16384, v177
    s_mov_b32 m0, 0
    s_nop 0
    buffer_load_dwordx4 v178, s[32:35], 0 offen lds
MK_L1H:
    s_lshl_b32 s79, s72, 11
    s_add_u32 m0, s79, 1024
    s_mov_b32 s77, 0
    buffer_load_dwordx4 v177, s[32:35], s77 offen lds
    s_add_u32 m0, s79, 2048
    s_mov_b32 s77, 16384
    buffer_load_dwordx4 v177, s[32:35], s77 offen lds
    s_add_u32 m0, s79, 17408
    s_mov_b32 s77, 0
    buffer_load_dwordx4 v177, s[36:39], s77 offen lds
    s_add_u32 m0, s79, 18432
    s_mov_b32 s77, 16384
    buffer_load_dwordx4 v177, s[36:39], s77 offen lds
    s_branch MK_L1D
MK_L1A:
    s_cmp_eq_u32 s47, 2
    s_cbranch_scc0 MK_L1B
    ds_read_b32 v179, v239 offset:640
    ds_read_b32 v180, v239 offset:768
    ds_read_b32 v181, v239 offset:896
    ds_read_b32 v182, v239 offset:1024
    ds_read_b32 v183, v239 offset:1152
    ds_read_b32 v184, v239 offset:1280
    ds_read_b32 v185, v239 offset:1408
    ds_read_b32 v186, v239 offset:1536
    ds_read_b32 v187, v239 offset:1664
    ds_read_b32 v188, v239 offset:1792
    ds_read_b32 v189, v239 offset:1920
    ds_read_b32 v190, v239 offset:17408
    ds_read_b32 v191, v239 offset:17536
    ds_read_b32 v192, v239 offset:17664
    ds_read_b32 v193, v239 offset:17792
    ds_read_b32 v194, v239 offset:17920
    ds_read_b32 v195, v239 offset:18048
    ds_read_b32 v196, v239 offset:18176
    ds_read_b32 v197, v239 offset:18304
    s_waitcnt lgkmcnt(0)
    v_lshlrev_b32 v198, 16, v232
    v_and_b32 v199, 0xffff0000, v232
    v_lshlrev_b32 v200, 16, v233
    v_and_b32 v201, 0xffff0000, v233
    v_lshlrev_b32 v202, 16, v234
    v_and_b32 v203, 0xffff0000, v234
    v_lshlrev_b32 v204, 16, v235
    v_and_b32 v205, 0xffff0000, v235
    v_lshlrev_b32 v206, 16, v179
    v_and_b32 v207, 0xffff0000, v179
    v_lshlrev_b32 v208, 16, v180
    v_and_b32 v209, 0xffff0000, v180
    v_lshlrev_b32 v210, 16, v181
    v_and_b32 v211, 0xffff0000, v181
    v_lshlrev_b32 v212, 16, v182
    v_and_b32 v213, 0xffff0000, v182
    v_lshlrev_b32 v214, 16, v183
    v_and_b32 v215, 0xffff0000, v183
    v_mul_f32 v232, v206, v201
    v_fmac_f32 v232, v208, v200
    v_fmac_f32 v232, v210, v199
    v_fmac_f32 v232, v212, v198
    v_mul_f32 v233, v207, v205
    v_fmac_f32 v233, v209, v204
    v_fmac_f32 v233, v211, v203
    v_fmac_f32 v233, v213, v202
    v_lshlrev_b32 v236, 16, v190
    v_and_b32 v237, 0xffff0000, v190
    v_mul_f32 v232, v232, v236
    v_mul_f32 v233, v233, v237
    v_mul_f32 v234, v208, v201
    v_fmac_f32 v234, v210, v200
    v_fmac_f32 v234, v212, v199
    v_fmac_f32 v234, v214, v198
    v_mul_f32 v235, v209, v205
    v_fmac_f32 v235, v211, v204
    v_fmac_f32 v235, v213, v203
    v_fmac_f32 v235, v215, v202
    v_lshlrev_b32 v236, 16, v191
    v_and_b32 v237, 0xffff0000, v191
    v_mul_f32 v234, v234, v236
    v_mul_f32 v235, v235, v237
    v_cvt_pk_bf16_f32 v171, v234, v232
    v_cvt_pk_bf16_f32 v175, v235, v233
    v_lshlrev_b32 v206, 16, v184
    v_and_b32 v207, 0xffff0000, v184
    v_lshlrev_b32 v208, 16, v185
    v_and_b32 v209, 0xffff0000, v185
    v_mul_f32 v232, v210, v201
    v_fmac_f32 v232, v212, v200
    v_fmac_f32 v232, v214, v199
    v_fmac_f32 v232, v206, v198
    v_mul_f32 v233, v211, v205
    v_fmac_f32 v233, v213, v204
    v_fmac_f32 v233, v215, v203
    v_fmac_f32 v233, v207, v202
    v_lshlrev_b32 v236, 16, v192
    v_and_b32 v237, 0xffff0000, v192
    v_mul_f32 v232, v232, v236
    v_mul_f32 v233, v233, v237
    v_mul_f32 v234, v212, v201
    v_fmac_f32 v234, v214, v200
    v_fmac_f32 v234, v206, v199
    v_fmac_f32 v234, v208, v198
    v_mul_f32 v235, v213, v205
    v_fmac_f32 v235, v215, v204
    v_fmac_f32 v235, v207, v203
    v_fmac_f32 v235, v209, v202
    v_lshlrev_b32 v236, 16, v193
    v_and_b32 v237, 0xffff0000, v193
    v_mul_f32 v234, v234, v236
    v_mul_f32 v235, v235, v237
    v_cvt_pk_bf16_f32 v170, v234, v232
    v_cvt_pk_bf16_f32 v174, v235, v233
    s_branch MK_L1D
MK_L1B:
    s_cmp_eq_u32 s47, 3
    s_cbranch_scc0 MK_L1C
    v_lshrrev_b32 v206, 4, v1
    s_lshl_b32 s79, s72, 3
    v_add_u32 v206, s79, v206
    v_mul_u32_u24 v207, 272, v206
    v_and_b32 v208, 15, v1
    v_lshlrev_b32 v208, 4, v208
    v_add_u32 v207, v207, v208
    ds_read_b128 v[168:171], v207 offset:33792
    ds_read_b128 v[172:175], v207 offset:34880
    s_mov_b32 s79, 4224
    v_mul_lo_u32 v206, v206, s79
    v_add_u32 v206, v206, v208
    s_mul_i32 s77, s74, 270336
    s_lshl_b32 s78, s73, 8
    s_sub_u32 s77, s77, s78
    s_add_u32 s77, s77, 4198144
    s_add_u32 s78, s77, 16896
    s_waitcnt lgkmcnt(0)
    buffer_store_dwordx4 v[168:171], v206, s[60:63], s77 offen sc1
    buffer_store_dwordx4 v[172:175], v206, s[60:63], s78 offen sc1
    s_cmp_eq_u32 s73, 0
    s_cbranch_scc0 MK_L1D
    s_cmp_lt_u32 s72, 4
    s_cbranch_scc0 MK_L1D
    v_mov_b32 v232, 0
    v_mov_b32 v233, 0
    v_mov_b32 v234, 0
    v_mov_b32 v235, 0
    v_lshrrev_b32 v210, 2, v1
    s_lshl_b32 s77, s72, 4
    v_add_u32 v210, s77, v210
    s_mov_b32 s78, 4224
    v_mul_lo_u32 v210, v210, s78
    v_and_b32 v211, 3, v1
    v_lshlrev_b32 v211, 4, v211
    v_add_u32 v210, v210, v211
    s_mul_i32 s77, s74, 270336
    s_add_u32 s77, s77, 4198400
    buffer_store_dwordx4 v[232:235], v210, s[60:63], s77 offen sc1
    s_branch MK_L1D
MK_L1C:
    s_cmp_eq_u32 s47, 5
    s_cbranch_scc0 MK_L1E
    s_lshl_b32 s79, s2, 2
    s_add_u32 s79, s79, s75
    s_lshl_b32 s79, s79, 12
    s_lshl_b32 s78, s76, 11
    s_add_u32 s79, s79, s78
    s_add_u32 m0, s53, 8832
    s_add_u32 s78, s79, 0
    buffer_load_dwordx4 v166, s[64:67], s78 offen lds
    s_add_u32 m0, s53, 9856
    s_add_u32 s78, s79, 1024
    buffer_load_dwordx4 v166, s[64:67], s78 offen lds
    s_branch MK_L1D
MK_L1E:
    s_cmp_eq_u32 s47, 6
    s_cbranch_scc0 MK_L1F
    s_lshr_b32 s79, s2, 4
    s_lshl_b32 s79, s79, 8
    s_add_u32 s79, s79, 13172736
    v_mov_b32 v177, 0
    buffer_load_dword v176, v177, s[60:63], s79 offen sc1
    s_branch MK_L1D
MK_L1F:
    v_readfirstlane_b32 s79, v176
    s_nop 3
    s_cmp_ge_u32 s79, 16
    s_cbranch_scc0 MK_L1D
    s_mov_b32 s50, 1
    s_add_u32 m0, s53, 0
    s_add_u32 s78, s52, 0
    buffer_load_dwordx4 v166, s[60:63], s78 offen sc1 lds
    s_add_u32 m0, s53, 1024
    s_add_u32 s78, s52, 1024
    buffer_load_dwordx4 v166, s[60:63], s78 offen sc1 lds
    s_add_u32 m0, s53, 4160
    s_add_u32 s78, s52, 2
    buffer_load_dwordx4 v166, s[60:63], s78 offen sc1 lds
    s_add_u32 m0, s53, 5184
    s_add_u32 s78, s52, 1026
    buffer_load_dwordx4 v166, s[60:63], s78 offen sc1 lds
MK_L1D:
    v_mfma_f32_32x32x16_bf16 v[20:35], v[124:127], v[248:251], v[84:99]
    v_exp_f32 v12, v12
    v_exp_f32 v13, v13
    v_exp_f32 v14, v14
    v_mfma_f32_32x32x16_bf16 v[20:35], v[128:131], v[252:255], v[20:35]
    v_exp_f32 v15, v15
    v_exp_f32 v16, v16
    v_exp_f32 v17, v17
    v_exp_f32 v18, v18
    v_exp_f32 v19, v19
    s_waitcnt lgkmcnt(2)
    v_smfmac_f32_32x32x32_bf16 v[36:51], v[140:143], v[4:11], v160
    v_exp_f32 v20, v20
    v_exp_f32 v21, v21
    v_exp_f32 v22, v22
    v_smfmac_f32_32x32x32_bf16 v[36:51], v[144:147], v[12:19], v160
    v_exp_f32 v23, v23
    v_exp_f32 v24, v24
    v_exp_f32 v25, v25
    v_smfmac_f32_16x16x64_bf16 v[148:151], v[156:159], v[4:11], v160
    v_exp_f32 v26, v26
    v_smfmac_f32_16x16x64_bf16 v[148:151], v[156:159], v[12:19], v160
    v_exp_f32 v27, v27
    s_waitcnt lgkmcnt(0)
    v_mfma_f32_32x32x16_bf16 v[4:19], v[116:119], v[240:243], v[68:83]
    v_exp_f32 v28, v28
    v_exp_f32 v29, v29
    v_exp_f32 v30, v30
    v_mfma_f32_32x32x16_bf16 v[4:19], v[120:123], v[244:247], v[4:19]
    v_exp_f32 v31, v31
    v_exp_f32 v32, v32
    v_exp_f32 v33, v33
    v_exp_f32 v34, v34
    v_exp_f32 v35, v35
    ds_read_b128 v[132:135], v161 offset:10240
    ds_read_b128 v[136:139], v161 offset:11264
    ds_read_b128 v[124:127], v161 offset:12288
    ds_read_b128 v[128:131], v161 offset:13312
    s_setprio 0
    v_smfmac_f32_32x32x32_bf16 v[52:67], v[140:143], v[20:27], v160
    v_exp_f32 v4, v4
    v_exp_f32 v5, v5
    v_exp_f32 v6, v6
    v_smfmac_f32_32x32x32_bf16 v[52:67], v[144:147], v[28:35], v160
    v_exp_f32 v7, v7
    v_exp_f32 v8, v8
    v_exp_f32 v9, v9
    v_smfmac_f32_16x16x64_bf16 v[152:155], v[156:159], v[20:27], v160
    v_exp_f32 v10, v10
    v_smfmac_f32_16x16x64_bf16 v[152:155], v[156:159], v[28:35], v160
    v_exp_f32 v11, v11
    s_bitcmp1_b32 s41, s47
    s_cbranch_scc0 MK_L2D
    v_lshlrev_b32 v210, 16, v186
    v_and_b32 v211, 0xffff0000, v186
    v_lshlrev_b32 v212, 16, v187
    v_and_b32 v213, 0xffff0000, v187
    v_mul_f32 v232, v214, v201
    v_fmac_f32 v232, v206, v200
    v_fmac_f32 v232, v208, v199
    v_fmac_f32 v232, v210, v198
    v_mul_f32 v233, v215, v205
    v_fmac_f32 v233, v207, v204
    v_fmac_f32 v233, v209, v203
    v_fmac_f32 v233, v211, v202
    v_lshlrev_b32 v236, 16, v194
    v_and_b32 v237, 0xffff0000, v194
    v_mul_f32 v232, v232, v236
    v_mul_f32 v233, v233, v237
    v_mul_f32 v234, v206, v201
    v_fmac_f32 v234, v208, v200
    v_fmac_f32 v234, v210, v199
    v_fmac_f32 v234, v212, v198
    v_mul_f32 v235, v207, v205
    v_fmac_f32 v235, v209, v204
    v_fmac_f32 v235, v211, v203
    v_fmac_f32 v235, v213, v202
    v_lshlrev_b32 v236, 16, v195
    v_and_b32 v237, 0xffff0000, v195
    v_mul_f32 v234, v234, v236
    v_mul_f32 v235, v235, v237
    v_cvt_pk_bf16_f32 v169, v234, v232
    v_cvt_pk_bf16_f32 v173, v235, v233
    v_lshlrev_b32 v214, 16, v188
    v_and_b32 v215, 0xffff0000, v188
    v_lshlrev_b32 v206, 16, v189
    v_and_b32 v207, 0xffff0000, v189
    v_mul_f32 v232, v208, v201
    v_fmac_f32 v232, v210, v200
    v_fmac_f32 v232, v212, v199
    v_fmac_f32 v232, v214, v198
    v_mul_f32 v233, v209, v205
    v_fmac_f32 v233, v211, v204
    v_fmac_f32 v233, v213, v203
    v_fmac_f32 v233, v215, v202
    v_lshlrev_b32 v236, 16, v196
    v_and_b32 v237, 0xffff0000, v196
    v_mul_f32 v232, v232, v236
    v_mul_f32 v233, v233, v237
    v_mul_f32 v234, v210, v201
    v_fmac_f32 v234, v212, v200
    v_fmac_f32 v234, v214, v199
    v_fmac_f32 v234, v206, v198
    v_mul_f32 v235, v211, v205
    v_fmac_f32 v235, v213, v204
    v_fmac_f32 v235, v215, v203
    v_fmac_f32 v235, v207, v202
    v_lshlrev_b32 v236, 16, v197
    v_and_b32 v237, 0xffff0000, v197
    v_mul_f32 v234, v234, v236
    v_mul_f32 v235, v235, v237
    v_cvt_pk_bf16_f32 v168, v234, v232
    v_cvt_pk_bf16_f32 v172, v235, v233
    v_and_b32 v206, 31, v1
    v_mul_u32_u24 v206, 544, v206
    v_lshrrev_b32 v207, 5, v1
    s_lshl_b32 s79, s72, 1
    v_add_u32 v207, s79, v207
    v_sub_u32 v207, 15, v207
    v_lshlrev_b32 v207, 4, v207
    v_add_u32 v206, v206, v207
    ds_write_b128 v206, v[168:171] offset:33792
    ds_write_b128 v206, v[172:175] offset:34064
MK_L2D:
    v_mfma_f32_32x32x16_bf16 v[20:35], v[116:119], v[248:251], v[84:99]
    v_exp_f32 v12, v12
    v_exp_f32 v13, v13
    v_exp_f32 v14, v14
    v_mfma_f32_32x32x16_bf16 v[20:35], v[120:123], v[252:255], v[20:35]
    v_exp_f32 v15, v15
    v_exp_f32 v16, v16
    v_exp_f32 v17, v17
    v_exp_f32 v18, v18
    v_exp_f32 v19, v19
    s_waitcnt lgkmcnt(2)
    v_smfmac_f32_32x32x32_bf16 v[36:51], v[132:135], v[4:11], v160
    v_exp_f32 v20, v20
    v_exp_f32 v21, v21
    v_exp_f32 v22, v22
    v_smfmac_f32_32x32x32_bf16 v[36:51], v[136:139], v[12:19], v160
    v_exp_f32 v23, v23
    v_exp_f32 v24, v24
    v_exp_f32 v25, v25
    v_smfmac_f32_16x16x64_bf16 v[148:151], v[156:159], v[4:11], v160
    v_exp_f32 v26, v26
    v_smfmac_f32_16x16x64_bf16 v[148:151], v[156:159], v[12:19], v160
    v_exp_f32 v27, v27
    s_waitcnt lgkmcnt(0)
    v_mfma_f32_32x32x16_bf16 v[4:19], v[124:127], v[240:243], v[68:83]
    v_exp_f32 v28, v28
    v_exp_f32 v29, v29
    v_exp_f32 v30, v30
    v_mfma_f32_32x32x16_bf16 v[4:19], v[128:131], v[244:247], v[4:19]
    v_exp_f32 v31, v31
    v_exp_f32 v32, v32
    v_exp_f32 v33, v33
    v_exp_f32 v34, v34
    v_exp_f32 v35, v35
    s_bitcmp1_b32 s42, s47
    s_cbranch_scc1 MK_WS
    s_waitcnt vmcnt(0)
MK_W2D:
    s_barrier
    s_cmp_eq_u32 s98, s47
    s_cbranch_scc0 MK_NOAA
    s_add_u32 s79, s74, 0
    s_lshl_b32 s77, s79, 8
    s_add_u32 s77, s77, 13172736
    v_mov_b32 v177, 0
    v_mov_b32 v178, 1
    s_mov_b32 exec_lo, 0x1
    s_mov_b32 exec_hi, 0
    buffer_atomic_add v178, v177, s[60:63], s77 offen sc1
    s_mov_b64 exec, -1
MK_NOAA:
    s_cmp_lt_u32 s47, 6
    s_cselect_b32 s48, 1, 0
    s_add_u32 s45, s45, 32768
    s_add_u32 s46, s55, s51
    s_cmp_eq_u32 s48, 0
    s_cbranch_scc1 MK_DP22
    s_add_u32 m0, s46, 0
    s_add_u32 s78, s45, 0
    buffer_load_dwordx4 v166, s[60:63], s78 offen sc1 lds
MK_DP22:
    ds_read_b128 v[140:143], v161 offset:14336
    ds_read_b128 v[144:147], v161 offset:15360
    ds_read_b128 v[116:119], v162
    ds_read_b128 v[120:123], v162 offset:1024
    s_setprio 3
    v_smfmac_f32_32x32x32_bf16 v[52:67], v[132:135], v[20:27], v160
    v_exp_f32 v4, v4
    v_exp_f32 v5, v5
    v_exp_f32 v6, v6
    v_smfmac_f32_32x32x32_bf16 v[52:67], v[136:139], v[28:35], v160
    v_exp_f32 v7, v7
    v_exp_f32 v8, v8
    v_exp_f32 v9, v9
    v_smfmac_f32_16x16x64_bf16 v[152:155], v[156:159], v[20:27], v160
    v_exp_f32 v10, v10
    v_smfmac_f32_16x16x64_bf16 v[152:155], v[156:159], v[28:35], v160
    v_exp_f32 v11, v11
    v_mfma_f32_32x32x16_bf16 v[20:35], v[124:127], v[248:251], v[84:99]
    v_exp_f32 v12, v12
    v_exp_f32 v13, v13
    v_exp_f32 v14, v14
    v_mfma_f32_32x32x16_bf16 v[20:35], v[128:131], v[252:255], v[20:35]
    v_exp_f32 v15, v15
    v_exp_f32 v16, v16
    v_exp_f32 v17, v17
    v_exp_f32 v18, v18
    v_exp_f32 v19, v19
    s_waitcnt lgkmcnt(2)
    v_smfmac_f32_32x32x32_bf16 v[36:51], v[140:143], v[4:11], v160
    v_exp_f32 v20, v20
    v_exp_f32 v21, v21
    v_exp_f32 v22, v22
    v_smfmac_f32_32x32x32_bf16 v[36:51], v[144:147], v[12:19], v160
    v_exp_f32 v23, v23
    v_exp_f32 v24, v24
    v_exp_f32 v25, v25
    v_smfmac_f32_16x16x64_bf16 v[148:151], v[156:159], v[4:11], v160
    v_exp_f32 v26, v26
    v_smfmac_f32_16x16x64_bf16 v[148:151], v[156:159], v[12:19], v160
    v_exp_f32 v27, v27
    s_cmp_eq_u32 s48, 0
    s_cbranch_scc1 MK_DP23
    s_add_u32 m0, s46, 1024
    s_add_u32 s78, s45, 1024
    buffer_load_dwordx4 v166, s[60:63], s78 offen sc1 lds
MK_DP23:
    s_waitcnt lgkmcnt(0)
    v_mfma_f32_32x32x16_bf16 v[4:19], v[116:119], v[240:243], v[68:83]
    v_exp_f32 v28, v28
    v_exp_f32 v29, v29
    v_exp_f32 v30, v30
    v_mfma_f32_32x32x16_bf16 v[4:19], v[120:123], v[244:247], v[4:19]
    v_exp_f32 v31, v31
    v_exp_f32 v32, v32
    v_exp_f32 v33, v33
    v_exp_f32 v34, v34
    v_exp_f32 v35, v35
    v_mov_b32 v161, v162
    s_mov_b32 s77, s43
    s_mov_b32 s43, s54
    s_mov_b32 s54, s55
    s_mov_b32 s55, s77
    v_add_u32 v162, s54, v163
    s_add_u32 s47, s47, 1
    s_cmp_lt_u32 s47, 8
    s_cbranch_scc1 MK_LOOP
    s_branch MK_LOOPX
MK_WS:
    s_cmp_eq_u32 s47, 0
    s_cbranch_scc0 MK_WS2
    s_waitcnt vmcnt(4)
    s_branch MK_W2D
MK_WS2:
    s_waitcnt vmcnt(2)
    s_branch MK_W2D
MK_LOOPX:
    s_setprio 0
    v_smfmac_f32_32x32x32_bf16 v[52:67], v[140:143], v[20:27], v160
    v_smfmac_f32_32x32x32_bf16 v[52:67], v[144:147], v[28:35], v160
    v_smfmac_f32_16x16x64_bf16 v[152:155], v[156:159], v[20:27], v160
    v_smfmac_f32_16x16x64_bf16 v[152:155], v[156:159], v[28:35], v160
    s_nop 7
    s_nop 7
    v_bfe_u32 v2, v1, 4, 1
    v_cmp_eq_u32 vcc, 1, v2
    s_nop 1
    v_cndmask_b32 v148, v148, v149, vcc
    v_cndmask_b32 v152, v152, v153, vcc
    s_cmp_eq_u32 s49, 0
    s_cbranch_scc0 MK_NOFLAG
    v_mov_b32 v2, 0x5f800000
    v_cmp_nlt_f32 vcc, v148, v2
    s_mov_b64 s[70:71], vcc
    v_cmp_nlt_f32 vcc, v152, v2
    s_or_b64 s[70:71], s[70:71], vcc
    s_cmp_eq_u64 s[70:71], 0
    s_cbranch_scc1 MK_NOFLAG
    v_mov_b32 v2, 51712
    v_mov_b32 v3, 1
    ds_write_b32 v2, v3
MK_NOFLAG:
    s_lshl_b32 s77, s72, 12
    s_add_u32 s77, s77, 122880
    v_lshlrev_b32 v2, 4, v1
    v_add_u32 v2, s77, v2
    s_lshl_b32 s77, s72, 9
    s_add_u32 s77, s77, 151552
    v_lshlrev_b32 v3, 3, v1
    v_add_u32 v3, s77, v3
    s_cmp_eq_u32 s76, 0
    s_cbranch_scc0 MK_X1
    ds_write_b128 v2, v[52:55] offset:0
    ds_write_b128 v2, v[56:59] offset:1024
    ds_write_b128 v2, v[60:63] offset:2048
    ds_write_b128 v2, v[64:67] offset:3072
    v_mov_b32 v168, v152
    v_mov_b32 v169, v84
    ds_write_b64 v3, v[168:169] offset:4096
    s_branch MK_X2
MK_X1:
    ds_write_b128 v2, v[36:39] offset:0
    ds_write_b128 v2, v[40:43] offset:1024
    ds_write_b128 v2, v[44:47] offset:2048
    ds_write_b128 v2, v[48:51] offset:3072
    v_mov_b32 v168, v148
    v_mov_b32 v169, v68
    ds_write_b64 v3, v[168:169] offset:4096
    s_waitcnt lgkmcnt(0)
    v_mov_b32 v36, v52
    v_mov_b32 v37, v53
    v_mov_b32 v38, v54
    v_mov_b32 v39, v55
    v_mov_b32 v40, v56
    v_mov_b32 v41, v57
    v_mov_b32 v42, v58
    v_mov_b32 v43, v59
    v_mov_b32 v44, v60
    v_mov_b32 v45, v61
    v_mov_b32 v46, v62
    v_mov_b32 v47, v63
    v_mov_b32 v48, v64
    v_mov_b32 v49, v65
    v_mov_b32 v50, v66
    v_mov_b32 v51, v67
    v_mov_b32 v148, v152
    v_mov_b32 v68, v84
MK_X2:
    s_xor_b32 s79, s72, 4
    s_lshl_b32 s77, s79, 12
    s_add_u32 s77, s77, 122880
    v_lshlrev_b32 v2, 4, v1
    v_add_u32 v2, s77, v2
    s_lshl_b32 s77, s79, 9
    s_add_u32 s77, s77, 151552
    v_lshlrev_b32 v3, 3, v1
    v_add_u32 v3, s77, v3
    s_waitcnt lgkmcnt(0)
    s_barrier
    ds_read_b128 v[4:7], v2 offset:0
    ds_read_b128 v[8:11], v2 offset:1024
    ds_read_b128 v[12:15], v2 offset:2048
    ds_read_b128 v[16:19], v2 offset:3072
    ds_read_b64 v[168:169], v3 offset:4096
    v_mov_b32 v173, 51712
    ds_read_b32 v174, v173
    s_waitcnt lgkmcnt(0)
    v_readfirstlane_b32 s77, v174
    s_nop 3
    s_cmp_eq_u32 s77, 0
    s_cbranch_scc1 MK_MERGE
    s_cmp_eq_u32 s49, 0
    s_cbranch_scc0 MK_MERGE
    s_waitcnt vmcnt(0)
    s_barrier
    s_mov_b32 s49, 1
    s_add_u32 s45, s51, 12845056
    s_add_u32 s46, s51, 122880
    s_add_u32 m0, s46, 0
    s_add_u32 s78, s45, 0
    buffer_load_dwordx4 v166, s[60:63], s78 offen sc1 lds
    s_add_u32 m0, s46, 1024
    s_add_u32 s78, s45, 1024
    buffer_load_dwordx4 v166, s[60:63], s78 offen sc1 lds
    s_add_u32 m0, s46, 2048
    s_add_u32 s78, s45, 2048
    buffer_load_dwordx4 v166, s[60:63], s78 offen sc1 lds
    s_add_u32 m0, s46, 3072
    s_add_u32 s78, s45, 3072
    buffer_load_dwordx4 v166, s[60:63], s78 offen sc1 lds
    s_add_u32 s45, s45, 32768
    s_add_u32 s46, s51, 53248
    s_add_u32 m0, s46, 0
    s_add_u32 s78, s45, 0
    buffer_load_dwordx4 v166, s[60:63], s78 offen sc1 lds
    s_add_u32 m0, s46, 1024
    s_add_u32 s78, s45, 1024
    buffer_load_dwordx4 v166, s[60:63], s78 offen sc1 lds
    s_add_u32 m0, s46, 2048
    s_add_u32 s78, s45, 2048
    buffer_load_dwordx4 v166, s[60:63], s78 offen sc1 lds
    s_add_u32 m0, s46, 3072
    s_add_u32 s78, s45, 3072
    buffer_load_dwordx4 v166, s[60:63], s78 offen sc1 lds
    v_mov_b32 v68, 0xff800000
    v_mov_b32 v84, 0xff800000
    s_mov_b32 s47, 0
MK_MAXLOOP:
    s_lshr_b32 s77, s47, 2
    s_lshl_b32 s77, s77, 3
    s_and_b32 s78, s47, 3
    s_add_u32 s77, s77, s78
    s_lshl_b32 s78, s76, 2
    s_add_u32 s77, s77, s78
    s_lshl_b32 s77, s77, 12
    s_add_u32 s77, s77, 12845056
    buffer_load_dwordx4 v[116:119], v166, s[60:63], s77 offen sc1
    buffer_load_dwordx4 v[120:123], v166, s[60:63], s77 offen offset:1024 sc1
    s_waitcnt vmcnt(0)
    v_mfma_f32_32x32x16_bf16 v[4:19], v[116:119], v[240:243], 0
    v_mfma_f32_32x32x16_bf16 v[20:35], v[116:119], v[248:251], 0
    v_mfma_f32_32x32x16_bf16 v[4:19], v[120:123], v[244:247], v[4:19]
    v_mfma_f32_32x32x16_bf16 v[20:35], v[120:123], v[252:255], v[20:35]
    s_nop 7
    s_nop 7
    v_max3_f32 v68, v68, v4, v5
    v_max3_f32 v68, v68, v6, v7
    v_max3_f32 v68, v68, v8, v9
    v_max3_f32 v68, v68, v10, v11
    v_max3_f32 v68, v68, v12, v13
    v_max3_f32 v68, v68, v14, v15
    v_max3_f32 v68, v68, v16, v17
    v_max3_f32 v68, v68, v18, v19
    v_max3_f32 v84, v84, v20, v21
    v_max3_f32 v84, v84, v22, v23
    v_max3_f32 v84, v84, v24, v25
    v_max3_f32 v84, v84, v26, v27
    v_max3_f32 v84, v84, v28, v29
    v_max3_f32 v84, v84, v30, v31
    v_max3_f32 v84, v84, v32, v33
    v_max3_f32 v84, v84, v34, v35
    s_add_u32 s47, s47, 1
    s_cmp_lt_u32 s47, 32
    s_cbranch_scc1 MK_MAXLOOP
    v_mov_b32 v2, v68
    s_nop 1
    v_permlane32_swap_b32 v2, v68
    s_nop 1
    v_max_f32 v68, v68, v2
    v_mov_b32 v2, v84
    s_nop 1
    v_permlane32_swap_b32 v2, v84
    s_nop 1
    v_max_f32 v84, v84, v2
    v_sub_f32 v68, 0, v68
    v_mov_b32 v69, v68
    v_mov_b32 v70, v68
    v_mov_b32 v71, v68
    v_mov_b32 v72, v68
    v_mov_b32 v73, v68
    v_mov_b32 v74, v68
    v_mov_b32 v75, v68
    v_mov_b32 v76, v68
    v_mov_b32 v77, v68
    v_mov_b32 v78, v68
    v_mov_b32 v79, v68
    v_mov_b32 v80, v68
    v_mov_b32 v81, v68
    v_mov_b32 v82, v68
    v_mov_b32 v83, v68
    v_sub_f32 v84, 0, v84
    v_mov_b32 v85, v84
    v_mov_b32 v86, v84
    v_mov_b32 v87, v84
    v_mov_b32 v88, v84
    v_mov_b32 v89, v84
    v_mov_b32 v90, v84
    v_mov_b32 v91, v84
    v_mov_b32 v92, v84
    v_mov_b32 v93, v84
    v_mov_b32 v94, v84
    v_mov_b32 v95, v84
    v_mov_b32 v96, v84
    v_mov_b32 v97, v84
    v_mov_b32 v98, v84
    v_mov_b32 v99, v84
    v_mov_b32 v36, 0
    v_mov_b32 v52, 0
    v_mov_b32 v37, 0
    v_mov_b32 v53, 0
    v_mov_b32 v38, 0
    v_mov_b32 v54, 0
    v_mov_b32 v39, 0
    v_mov_b32 v55, 0
    v_mov_b32 v40, 0
    v_mov_b32 v56, 0
    v_mov_b32 v41, 0
    v_mov_b32 v57, 0
    v_mov_b32 v42, 0
    v_mov_b32 v58, 0
    v_mov_b32 v43, 0
    v_mov_b32 v59, 0
    v_mov_b32 v44, 0
    v_mov_b32 v60, 0
    v_mov_b32 v45, 0
    v_mov_b32 v61, 0
    v_mov_b32 v46, 0
    v_mov_b32 v62, 0
    v_mov_b32 v47, 0
    v_mov_b32 v63, 0
    v_mov_b32 v48, 0
    v_mov_b32 v64, 0
    v_mov_b32 v49, 0
    v_mov_b32 v65, 0
    v_mov_b32 v50, 0
    v_mov_b32 v66, 0
    v_mov_b32 v51, 0
    v_mov_b32 v67, 0
    v_mov_b32 v148, 0
    v_mov_b32 v152, 0
    v_mov_b32 v149, 0
    v_mov_b32 v153, 0
    v_mov_b32 v150, 0
    v_mov_b32 v154, 0
    v_mov_b32 v151, 0
    v_mov_b32 v155, 0
    v_mov_b32 v140, 0
    v_mov_b32 v141, 0
    v_mov_b32 v142, 0
    v_mov_b32 v143, 0
    v_mov_b32 v144, 0
    v_mov_b32 v145, 0
    v_mov_b32 v146, 0
    v_mov_b32 v147, 0
    s_waitcnt vmcnt(0)
    s_barrier
    v_add_u32 v161, 122880, v163
    ds_read_b128 v[116:119], v161
    ds_read_b128 v[120:123], v161 offset:1024
    s_waitcnt lgkmcnt(0)
    s_branch MK_ATT
MK_MERGE:
    v_min_f32 v170, v68, v169
    v_sub_f32 v171, v170, v68
    v_sub_f32 v172, v170, v169
    v_exp_f32 v171, v171
    v_exp_f32 v172, v172
    s_nop 0
    v_mul_f32 v148, v148, v171
    v_fmac_f32 v148, v168, v172
    v_rcp_f32 v148, v148
    s_nop 0
    v_mul_f32 v171, v171, v148
    v_mul_f32 v172, v172, v148
    v_mul_f32 v36, v36, v171
    v_fmac_f32 v36, v4, v172
    v_mul_f32 v37, v37, v171
    v_fmac_f32 v37, v5, v172
    v_mul_f32 v38, v38, v171
    v_fmac_f32 v38, v6, v172
    v_mul_f32 v39, v39, v171
    v_fmac_f32 v39, v7, v172
    v_mul_f32 v40, v40, v171
    v_fmac_f32 v40, v8, v172
    v_mul_f32 v41, v41, v171
    v_fmac_f32 v41, v9, v172
    v_mul_f32 v42, v42, v171
    v_fmac_f32 v42, v10, v172
    v_mul_f32 v43, v43, v171
    v_fmac_f32 v43, v11, v172
    v_mul_f32 v44, v44, v171
    v_fmac_f32 v44, v12, v172
    v_mul_f32 v45, v45, v171
    v_fmac_f32 v45, v13, v172
    v_mul_f32 v46, v46, v171
    v_fmac_f32 v46, v14, v172
    v_mul_f32 v47, v47, v171
    v_fmac_f32 v47, v15, v172
    v_mul_f32 v48, v48, v171
    v_fmac_f32 v48, v16, v172
    v_mul_f32 v49, v49, v171
    v_fmac_f32 v49, v17, v172
    v_mul_f32 v50, v50, v171
    v_fmac_f32 v50, v18, v172
    v_mul_f32 v51, v51, v171
    v_fmac_f32 v51, v19, v172
    v_cvt_pk_bf16_f32 v20, v36, v37
    v_cvt_pk_bf16_f32 v21, v38, v39
    v_cvt_pk_bf16_f32 v22, v40, v41
    v_cvt_pk_bf16_f32 v23, v42, v43
    v_cvt_pk_bf16_f32 v24, v44, v45
    v_cvt_pk_bf16_f32 v25, v46, v47
    v_cvt_pk_bf16_f32 v26, v48, v49
    v_cvt_pk_bf16_f32 v27, v50, v51
    s_nop 1
    v_permlane32_swap_b32 v20, v22
    v_permlane32_swap_b32 v21, v23
    v_permlane32_swap_b32 v24, v26
    v_permlane32_swap_b32 v25, v27
    s_lshl_b32 s77, s74, 7
    s_lshl_b32 s78, s76, 6
    s_add_u32 s77, s77, s78
    s_add_u32 s77, s77, 0
    buffer_store_dwordx4 v[20:23], v164, s[60:63], s77 offen sc1
    buffer_store_dwordx4 v[24:27], v164, s[60:63], s77 offen offset:32 sc1
    v_mov_b32 v189, v167
    s_cmp_eq_u32 s50, 1
    s_cbranch_scc1 MK_EOOK
    s_lshr_b32 s79, s2, 4
    s_lshl_b32 s79, s79, 8
    s_add_u32 s54, s79, 13172736
    v_lshlrev_b32 v185, 2, v1
    s_mov_b32 exec_lo, 0x1
    s_mov_b32 exec_hi, 0
    s_mov_b32 s78, 0x20000
MK_POLL24:
    buffer_load_dword v186, v185, s[60:63], s54 offen sc1
    s_waitcnt vmcnt(0)
    v_cmp_gt_u32 vcc, 16, v186
    s_cbranch_vccz MK_POLL24D
    s_sleep 1
    s_sub_u32 s78, s78, 1
    s_cmp_lg_u32 s78, 0
    s_cbranch_scc1 MK_POLL24
MK_POLL24D:
    s_mov_b64 exec, -1
    s_add_u32 m0, s53, 0
    s_add_u32 s78, s52, 0
    buffer_load_dwordx4 v166, s[60:63], s78 offen sc1 lds
    s_add_u32 m0, s53, 1024
    s_add_u32 s78, s52, 1024
    buffer_load_dwordx4 v166, s[60:63], s78 offen sc1 lds
    s_add_u32 m0, s53, 4160
    s_add_u32 s78, s52, 2
    buffer_load_dwordx4 v166, s[60:63], s78 offen sc1 lds
    s_add_u32 m0, s53, 5184
    s_add_u32 s78, s52, 1026
    buffer_load_dwordx4 v166, s[60:63], s78 offen sc1 lds
    s_waitcnt vmcnt(0)
MK_EOOK:
    s_mov_b32 s36, s22
    s_mov_b32 s37, s23
    s_mov_b32 s38, 0x200000
    s_mov_b32 s39, 0x20000
    s_mov_b32 s68, s0
    s_lshl_b32 s77, s72, 3
    v_lshrrev_b32 v185, 3, v1
    v_add_u32 v185, s77, v185
    v_lshlrev_b32 v185, 11, v185
    v_bfe_u32 v186, v1, 4, 1
    v_lshlrev_b32 v186, 2, v186
    v_and_b32 v187, 7, v1
    v_xor_b32 v186, v186, v187
    v_lshlrev_b32 v186, 4, v186
    v_add_u32 v185, v185, v186
    s_lshl_b32 s77, s74, 7
    v_add_u32 v188, s77, v185
    s_lshl_b32 s55, s72, 10
    s_cmp_eq_u32 s76, 0
    s_cbranch_scc0 MK_NOPAD
    v_lshlrev_b32 v185, 4, v1
    v_add_u32 v186, 4096, v185
    v_add_u32 v187, 8224, v185
    v_cmp_lt_u32 vcc, 1, v1
    s_nop 1
    v_cndmask_b32 v186, v186, v187, vcc
    v_add_u32 v187, 8256, v185
    v_cmp_lt_u32 vcc, 3, v1
    s_nop 1
    v_cndmask_b32 v186, v186, v187, vcc
    v_add_u32 v186, s44, v186
    v_mov_b32 v20, 0
    v_mov_b32 v21, 0
    v_mov_b32 v22, 0
    v_mov_b32 v23, 0
    s_mov_b32 exec_lo, -1
    s_mov_b32 exec_hi, 0xf
    ds_write_b128 v186, v[20:23]
    s_mov_b64 exec, -1
MK_NOPAD:
    v_and_b32 v185, 15, v1
    v_or_b32 v186, 1, v185
    v_sub_u32 v186, 2047, v186
    v_lshrrev_b32 v187, 5, v1
    v_lshlrev_b32 v187, 4, v187
    v_sub_u32 v186, v186, v187
    v_bfe_u32 v187, v1, 4, 1
    v_lshlrev_b32 v187, 3, v187
    v_add_u32 v186, v186, v187
    v_lshlrev_b32 v186, 1, v186
    v_and_b32 v187, 1, v185
    v_sub_u32 v187, 1, v187
    v_mul_u32_u24 v187, 4160, v187
    v_add_u32 v186, v186, v187
    s_lshl_b32 s77, s76, 8
    s_sub_u32 s77, s44, s77
    v_add_u32 v186, s77, v186
    v_subrev_u32 v180, 704, v186
    v_subrev_u32 v181, 1728, v186
    v_subrev_u32 v182, 2752, v186
    v_subrev_u32 v183, 3776, v186
    v_lshlrev_b32 v184, 5, v185
    v_lshrrev_b32 v187, 5, v1
    v_lshlrev_b32 v187, 5, v187
    v_sub_u32 v184, v184, v187
    v_bfe_u32 v187, v1, 4, 1
    v_lshlrev_b32 v187, 4, v187
    v_add_u32 v184, v184, v187
    s_add_u32 s77, s77, 8640
    v_add_u32 v184, s77, v184
    s_cmp_ge_u32 s72, 4
    s_cbranch_scc0 MK_NOPA
    s_lshl_b32 s77, s73, 7
    s_lshl_b32 s78, s75, 5
    s_add_u32 s77, s77, s78
    v_lshrrev_b32 v2, 3, v1
    v_add_u32 v2, s77, v2
    v_lshlrev_b32 v2, 11, v2
    v_lshrrev_b32 v3, 4, v1
    v_and_b32 v4, 7, v1
    v_xor_b32 v6, v4, v3
    v_xor_b32 v7, 4, v6
    v_lshlrev_b32 v6, 4, v6
    v_lshlrev_b32 v7, 4, v7
    v_add_u32 v6, v6, v2
    v_add_u32 v7, v7, v2
    v_add_u32 v7, 16384, v7
    s_lshl_b32 s77, s75, 4
    v_lshrrev_b32 v2, 3, v1
    v_add_u32 v2, s77, v2
    v_lshlrev_b32 v2, 11, v2
    v_and_b32 v3, 1, v3
    v_lshlrev_b32 v3, 2, v3
    v_xor_b32 v3, v4, v3
    v_lshlrev_b32 v3, 4, v3
    v_add_u32 v2, v2, v3
    s_lshl_b32 s77, s74, 7
    v_add_u32 v8, s77, v2
    s_lshl_b32 s3, s75, 12
    s_mov_b32 s56, s30
    s_mov_b32 s57, s31
    s_mov_b32 s58, 0x400000
    s_mov_b32 s59, 0x20000
MK_NOPA:
    s_waitcnt lgkmcnt(0)
    s_barrier
    ds_read2_b32 v[52:53], v180 offset0:176 offset1:177
    ds_read2_b32 v[54:55], v180 offset0:178 offset1:179
    ds_read_b128 v[116:119], v184 offset:192
    ds_read2_b32 v[56:57], v180 offset0:48 offset1:49
    ds_read2_b32 v[58:59], v180 offset0:50 offset1:51
    ds_read_b128 v[120:123], v184 offset:704
    ds_read2_b32 v[60:61], v181 offset0:176 offset1:177
    ds_read2_b32 v[62:63], v181 offset0:178 offset1:179
    ds_read_b128 v[124:127], v184 offset:1216
    ds_read2_b32 v[64:65], v181 offset0:48 offset1:49
    ds_read2_b32 v[66:67], v181 offset0:50 offset1:51
    ds_read_b128 v[128:131], v184 offset:1728
    ds_read2_b32 v[68:69], v182 offset0:176 offset1:177
    ds_read2_b32 v[70:71], v182 offset0:178 offset1:179
    ds_read_b128 v[132:135], v184 offset:2240
    ds_read2_b32 v[72:73], v182 offset0:48 offset1:49
    ds_read2_b32 v[74:75], v182 offset0:50 offset1:51
    ds_read_b128 v[136:139], v184 offset:2752
    ds_read2_b32 v[76:77], v183 offset0:176 offset1:177
    ds_read2_b32 v[78:79], v183 offset0:178 offset1:179
    ds_read_b128 v[140:143], v184 offset:3264
    ds_read2_b32 v[80:81], v183 offset0:48 offset1:49
    ds_read2_b32 v[82:83], v183 offset0:50 offset1:51
    ds_read_b128 v[144:147], v184 offset:3776
    s_waitcnt lgkmcnt(0)
    s_cmp_eq_u32 s76, 0
    s_cbranch_scc1 MK_CP25
    s_setprio 0
    s_branch MK_CP25D
MK_CP25:
    s_setprio 1
MK_CP25D:
    v_mfma_f32_16x16x32_bf16 v[20:23], v[52:55], v[116:119], 0
    v_mfma_f32_16x16x32_bf16 v[24:27], v[52:55], v[120:123], 0
    ds_read2_b32 v[84:85], v180 offset0:160 offset1:161
    v_mfma_f32_16x16x32_bf16 v[28:31], v[52:55], v[124:127], 0
    ds_read2_b32 v[86:87], v180 offset0:162 offset1:163
    v_mfma_f32_16x16x32_bf16 v[32:35], v[52:55], v[128:131], 0
    ds_read_b128 v[148:151], v184 offset:128
    v_mfma_f32_16x16x32_bf16 v[36:39], v[52:55], v[132:135], 0
    ds_read2_b32 v[88:89], v180 offset0:32 offset1:33
    v_mfma_f32_16x16x32_bf16 v[40:43], v[52:55], v[136:139], 0
    v_mfma_f32_16x16x32_bf16 v[44:47], v[52:55], v[140:143], 0
    ds_read2_b32 v[90:91], v180 offset0:34 offset1:35
    s_add_u32 s77, s68, 0
    s_and_b32 s77, s77, 15
    s_lshl_b32 s77, s77, 17
    s_add_u32 m0, s55, 53248
    s_nop 0
    buffer_load_dwordx4 v188, s[36:39], s77 offen lds
    v_mfma_f32_16x16x32_bf16 v[48:51], v[52:55], v[144:147], 0
    ds_read_b128 v[152:155], v184 offset:640
    v_mfma_f32_16x16x32_bf16 v[24:27], v[56:59], v[116:119], v[24:27]
    ds_read2_b32 v[92:93], v181 offset0:160 offset1:161
    v_mfma_f32_16x16x32_bf16 v[28:31], v[56:59], v[120:123], v[28:31]
    ds_read2_b32 v[94:95], v181 offset0:162 offset1:163
    v_mfma_f32_16x16x32_bf16 v[32:35], v[56:59], v[124:127], v[32:35]
    v_mfma_f32_16x16x32_bf16 v[36:39], v[56:59], v[128:131], v[36:39]
    ds_read_b128 v[156:159], v184 offset:1152
    v_mfma_f32_16x16x32_bf16 v[40:43], v[56:59], v[132:135], v[40:43]
    ds_read2_b32 v[96:97], v181 offset0:32 offset1:33
    v_mfma_f32_16x16x32_bf16 v[44:47], v[56:59], v[136:139], v[44:47]
    ds_read2_b32 v[98:99], v181 offset0:34 offset1:35
    v_mfma_f32_16x16x32_bf16 v[48:51], v[56:59], v[140:143], v[48:51]
    ds_read_b128 v[160:163], v184 offset:1664
    v_mfma_f32_16x16x32_bf16 v[28:31], v[60:63], v[116:119], v[28:31]
    v_mfma_f32_16x16x32_bf16 v[32:35], v[60:63], v[120:123], v[32:35]
    ds_read2_b32 v[100:101], v182 offset0:160 offset1:161
    s_add_u32 s77, s68, 1
    s_and_b32 s77, s77, 15
    s_lshl_b32 s77, s77, 17
    s_add_u32 m0, s55, 61440
    s_nop 0
    buffer_load_dwordx4 v188, s[36:39], s77 offen lds
    v_mfma_f32_16x16x32_bf16 v[36:39], v[60:63], v[124:127], v[36:39]
    ds_read2_b32 v[102:103], v182 offset0:162 offset1:163
    v_mfma_f32_16x16x32_bf16 v[40:43], v[60:63], v[128:131], v[40:43]
    ds_read_b128 v[164:167], v184 offset:2176
    v_mfma_f32_16x16x32_bf16 v[44:47], v[60:63], v[132:135], v[44:47]
    ds_read2_b32 v[104:105], v182 offset0:32 offset1:33
    v_mfma_f32_16x16x32_bf16 v[48:51], v[60:63], v[136:139], v[48:51]
    v_mfma_f32_16x16x32_bf16 v[32:35], v[64:67], v[116:119], v[32:35]
    ds_read2_b32 v[106:107], v182 offset0:34 offset1:35
    v_mfma_f32_16x16x32_bf16 v[36:39], v[64:67], v[120:123], v[36:39]
    ds_read_b128 v[168:171], v184 offset:2688
    v_mfma_f32_16x16x32_bf16 v[40:43], v[64:67], v[124:127], v[40:43]
    ds_read2_b32 v[108:109], v183 offset0:160 offset1:161
    v_mfma_f32_16x16x32_bf16 v[44:47], v[64:67], v[128:131], v[44:47]
    ds_read2_b32 v[110:111], v183 offset0:162 offset1:163
    v_mfma_f32_16x16x32_bf16 v[48:51], v[64:67], v[132:135], v[48:51]
    v_mfma_f32_16x16x32_bf16 v[36:39], v[68:71], v[116:119], v[36:39]
    ds_read_b128 v[172:175], v184 offset:3200
    s_add_u32 s77, s68, 2
    s_and_b32 s77, s77, 15
    s_lshl_b32 s77, s77, 17
    s_add_u32 m0, s55, 69632
    s_nop 0
    buffer_load_dwordx4 v188, s[36:39], s77 offen lds
    v_mfma_f32_16x16x32_bf16 v[40:43], v[68:71], v[120:123], v[40:43]
    ds_read2_b32 v[112:113], v183 offset0:32 offset1:33
    v_mfma_f32_16x16x32_bf16 v[44:47], v[68:71], v[124:127], v[44:47]
    ds_read2_b32 v[114:115], v183 offset0:34 offset1:35
    v_mfma_f32_16x16x32_bf16 v[48:51], v[68:71], v[128:131], v[48:51]
    ds_read_b128 v[176:179], v184 offset:3712
    v_mfma_f32_16x16x32_bf16 v[40:43], v[72:75], v[116:119], v[40:43]
    v_mfma_f32_16x16x32_bf16 v[44:47], v[72:75], v[120:123], v[44:47]
    v_mfma_f32_16x16x32_bf16 v[48:51], v[72:75], v[124:127], v[48:51]
    v_mfma_f32_16x16x32_bf16 v[44:47], v[76:79], v[116:119], v[44:47]
    v_mfma_f32_16x16x32_bf16 v[48:51], v[76:79], v[120:123], v[48:51]
    v_mfma_f32_16x16x32_bf16 v[48:51], v[80:83], v[116:119], v[48:51]
    s_waitcnt lgkmcnt(0)
    s_cmp_eq_u32 s76, 1
    s_cbranch_scc1 MK_CP26
    s_setprio 0
    s_branch MK_CP26D
MK_CP26:
    s_setprio 1
MK_CP26D:
    v_mfma_f32_16x16x32_bf16 v[20:23], v[84:87], v[148:151], v[20:23]
    v_mfma_f32_16x16x32_bf16 v[24:27], v[84:87], v[152:155], v[24:27]
    ds_read2_b32 v[52:53], v180 offset0:144 offset1:145
    v_mfma_f32_16x16x32_bf16 v[28:31], v[84:87], v[156:159], v[28:31]
    ds_read2_b32 v[54:55], v180 offset0:146 offset1:147
    v_mfma_f32_16x16x32_bf16 v[32:35], v[84:87], v[160:163], v[32:35]
    ds_read_b128 v[116:119], v184 offset:64
    v_mfma_f32_16x16x32_bf16 v[36:39], v[84:87], v[164:167], v[36:39]
    ds_read2_b32 v[56:57], v180 offset0:16 offset1:17
    v_mfma_f32_16x16x32_bf16 v[40:43], v[84:87], v[168:171], v[40:43]
    v_mfma_f32_16x16x32_bf16 v[44:47], v[84:87], v[172:175], v[44:47]
    ds_read2_b32 v[58:59], v180 offset0:18 offset1:19
    s_add_u32 s77, s68, 3
    s_and_b32 s77, s77, 15
    s_lshl_b32 s77, s77, 17
    s_add_u32 m0, s55, 77824
    s_nop 0
    buffer_load_dwordx4 v188, s[36:39], s77 offen lds
    v_mfma_f32_16x16x32_bf16 v[48:51], v[84:87], v[176:179], v[48:51]
    ds_read_b128 v[120:123], v184 offset:576
    v_mfma_f32_16x16x32_bf16 v[24:27], v[88:91], v[148:151], v[24:27]
    ds_read2_b32 v[60:61], v181 offset0:144 offset1:145
    v_mfma_f32_16x16x32_bf16 v[28:31], v[88:91], v[152:155], v[28:31]
    ds_read2_b32 v[62:63], v181 offset0:146 offset1:147
    v_mfma_f32_16x16x32_bf16 v[32:35], v[88:91], v[156:159], v[32:35]
    v_mfma_f32_16x16x32_bf16 v[36:39], v[88:91], v[160:163], v[36:39]
    ds_read_b128 v[124:127], v184 offset:1088
    v_mfma_f32_16x16x32_bf16 v[40:43], v[88:91], v[164:167], v[40:43]
    ds_read2_b32 v[64:65], v181 offset0:16 offset1:17
    v_mfma_f32_16x16x32_bf16 v[44:47], v[88:91], v[168:171], v[44:47]
    ds_read2_b32 v[66:67], v181 offset0:18 offset1:19
    v_mfma_f32_16x16x32_bf16 v[48:51], v[88:91], v[172:175], v[48:51]
    ds_read_b128 v[128:131], v184 offset:1600
    v_mfma_f32_16x16x32_bf16 v[28:31], v[92:95], v[148:151], v[28:31]
    v_mfma_f32_16x16x32_bf16 v[32:35], v[92:95], v[152:155], v[32:35]
    ds_read2_b32 v[68:69], v182 offset0:144 offset1:145
    s_add_u32 s77, s68, 4
    s_and_b32 s77, s77, 15
    s_lshl_b32 s77, s77, 17
    s_add_u32 m0, s55, 86016
    s_nop 0
    buffer_load_dwordx4 v188, s[36:39], s77 offen lds
    v_mfma_f32_16x16x32_bf16 v[36:39], v[92:95], v[156:159], v[36:39]
    ds_read2_b32 v[70:71], v182 offset0:146 offset1:147
    v_mfma_f32_16x16x32_bf16 v[40:43], v[92:95], v[160:163], v[40:43]
    ds_read_b128 v[132:135], v184 offset:2112
    v_mfma_f32_16x16x32_bf16 v[44:47], v[92:95], v[164:167], v[44:47]
    ds_read2_b32 v[72:73], v182 offset0:16 offset1:17
    v_mfma_f32_16x16x32_bf16 v[48:51], v[92:95], v[168:171], v[48:51]
    v_mfma_f32_16x16x32_bf16 v[32:35], v[96:99], v[148:151], v[32:35]
    ds_read2_b32 v[74:75], v182 offset0:18 offset1:19
    v_mfma_f32_16x16x32_bf16 v[36:39], v[96:99], v[152:155], v[36:39]
    ds_read_b128 v[136:139], v184 offset:2624
    v_mfma_f32_16x16x32_bf16 v[40:43], v[96:99], v[156:159], v[40:43]
    ds_read2_b32 v[76:77], v183 offset0:144 offset1:145
    v_mfma_f32_16x16x32_bf16 v[44:47], v[96:99], v[160:163], v[44:47]
    ds_read2_b32 v[78:79], v183 offset0:146 offset1:147
    v_mfma_f32_16x16x32_bf16 v[48:51], v[96:99], v[164:167], v[48:51]
    v_mfma_f32_16x16x32_bf16 v[36:39], v[100:103], v[148:151], v[36:39]
    ds_read_b128 v[140:143], v184 offset:3136
    s_add_u32 s77, s68, 5
    s_and_b32 s77, s77, 15
    s_lshl_b32 s77, s77, 17
    s_add_u32 m0, s55, 94208
    s_nop 0
    buffer_load_dwordx4 v188, s[36:39], s77 offen lds
    v_mfma_f32_16x16x32_bf16 v[40:43], v[100:103], v[152:155], v[40:43]
    ds_read2_b32 v[80:81], v183 offset0:16 offset1:17
    v_mfma_f32_16x16x32_bf16 v[44:47], v[100:103], v[156:159], v[44:47]
    ds_read2_b32 v[82:83], v183 offset0:18 offset1:19
    v_mfma_f32_16x16x32_bf16 v[48:51], v[100:103], v[160:163], v[48:51]
    ds_read_b128 v[144:147], v184 offset:3648
    v_mfma_f32_16x16x32_bf16 v[40:43], v[104:107], v[148:151], v[40:43]
    v_mfma_f32_16x16x32_bf16 v[44:47], v[104:107], v[152:155], v[44:47]
    v_mfma_f32_16x16x32_bf16 v[48:51], v[104:107], v[156:159], v[48:51]
    v_mfma_f32_16x16x32_bf16 v[44:47], v[108:111], v[148:151], v[44:47]
    v_mfma_f32_16x16x32_bf16 v[48:51], v[108:111], v[152:155], v[48:51]
    v_mfma_f32_16x16x32_bf16 v[48:51], v[112:115], v[148:151], v[48:51]
    s_waitcnt lgkmcnt(0)
    s_waitcnt vmcnt(6)
    v_mov_b32 v185, 163592
    v_mov_b32 v186, 1
    s_mov_b32 exec_lo, 0x1
    s_mov_b32 exec_hi, 0
    ds_add_rtn_u32 v187, v185, v186
    s_waitcnt lgkmcnt(0)
    s_mov_b64 exec, -1
    v_readfirstlane_b32 s77, v187
    s_nop 3
    s_cmp_eq_u32 s77, 7
    s_cbranch_scc0 MK_LA27
    s_add_u32 s79, s73, 24
    s_lshl_b32 s77, s79, 8
    s_add_u32 s77, s77, 13172736
    v_mov_b32 v185, 0
    v_mov_b32 v186, 1
    s_mov_b32 exec_lo, 0x1
    s_mov_b32 exec_hi, 0
    buffer_atomic_add v186, v185, s[60:63], s77 offen sc1
    s_mov_b64 exec, -1
MK_LA27:
    s_cmp_eq_u32 s76, 0
    s_cbranch_scc1 MK_CP28
    s_setprio 0
    s_branch MK_CP28D
MK_CP28:
    s_setprio 1
MK_CP28D:
    v_mfma_f32_16x16x32_bf16 v[20:23], v[52:55], v[116:119], v[20:23]
    v_mfma_f32_16x16x32_bf16 v[24:27], v[52:55], v[120:123], v[24:27]
    ds_read2_b32 v[84:85], v180 offset0:128 offset1:129
    v_mfma_f32_16x16x32_bf16 v[28:31], v[52:55], v[124:127], v[28:31]
    ds_read2_b32 v[86:87], v180 offset0:130 offset1:131
    v_mfma_f32_16x16x32_bf16 v[32:35], v[52:55], v[128:131], v[32:35]
    ds_read_b128 v[148:151], v184 offset:0
    v_mfma_f32_16x16x32_bf16 v[36:39], v[52:55], v[132:135], v[36:39]
    ds_read2_b32 v[88:89], v180 offset0:0 offset1:1
    v_mfma_f32_16x16x32_bf16 v[40:43], v[52:55], v[136:139], v[40:43]
    v_mfma_f32_16x16x32_bf16 v[44:47], v[52:55], v[140:143], v[44:47]
    ds_read2_b32 v[90:91], v180 offset0:2 offset1:3
    s_add_u32 s77, s68, 6
    s_and_b32 s77, s77, 15
    s_lshl_b32 s77, s77, 17
    s_add_u32 m0, s55, 102400
    s_nop 0
    buffer_load_dwordx4 v188, s[36:39], s77 offen lds
    v_mfma_f32_16x16x32_bf16 v[48:51], v[52:55], v[144:147], v[48:51]
    ds_read_b128 v[152:155], v184 offset:512
    v_mfma_f32_16x16x32_bf16 v[24:27], v[56:59], v[116:119], v[24:27]
    ds_read2_b32 v[92:93], v181 offset0:128 offset1:129
    v_mfma_f32_16x16x32_bf16 v[28:31], v[56:59], v[120:123], v[28:31]
    ds_read2_b32 v[94:95], v181 offset0:130 offset1:131
    v_mfma_f32_16x16x32_bf16 v[32:35], v[56:59], v[124:127], v[32:35]
    v_mfma_f32_16x16x32_bf16 v[36:39], v[56:59], v[128:131], v[36:39]
    ds_read_b128 v[156:159], v184 offset:1024
    v_mfma_f32_16x16x32_bf16 v[40:43], v[56:59], v[132:135], v[40:43]
    ds_read2_b32 v[96:97], v181 offset0:0 offset1:1
    v_mfma_f32_16x16x32_bf16 v[44:47], v[56:59], v[136:139], v[44:47]
    ds_read2_b32 v[98:99], v181 offset0:2 offset1:3
    v_mfma_f32_16x16x32_bf16 v[48:51], v[56:59], v[140:143], v[48:51]
    ds_read_b128 v[160:163], v184 offset:1536
    v_mfma_f32_16x16x32_bf16 v[28:31], v[60:63], v[116:119], v[28:31]
    v_mfma_f32_16x16x32_bf16 v[32:35], v[60:63], v[120:123], v[32:35]
    ds_read2_b32 v[100:101], v182 offset0:128 offset1:129
    s_add_u32 s77, s68, 7
    s_and_b32 s77, s77, 15
    s_lshl_b32 s77, s77, 17
    s_add_u32 m0, s55, 110592
    s_nop 0
    buffer_load_dwordx4 v188, s[36:39], s77 offen lds
    v_mfma_f32_16x16x32_bf16 v[36:39], v[60:63], v[124:127], v[36:39]
    ds_read2_b32 v[102:103], v182 offset0:130 offset1:131
    v_mfma_f32_16x16x32_bf16 v[40:43], v[60:63], v[128:131], v[40:43]
    ds_read_b128 v[164:167], v184 offset:2048
    v_mfma_f32_16x16x32_bf16 v[44:47], v[60:63], v[132:135], v[44:47]
    ds_read2_b32 v[104:105], v182 offset0:0 offset1:1
    v_mfma_f32_16x16x32_bf16 v[48:51], v[60:63], v[136:139], v[48:51]
    v_mfma_f32_16x16x32_bf16 v[32:35], v[64:67], v[116:119], v[32:35]
    ds_read2_b32 v[106:107], v182 offset0:2 offset1:3
    v_mfma_f32_16x16x32_bf16 v[36:39], v[64:67], v[120:123], v[36:39]
    ds_read_b128 v[168:171], v184 offset:2560
    v_mfma_f32_16x16x32_bf16 v[40:43], v[64:67], v[124:127], v[40:43]
    ds_read2_b32 v[108:109], v183 offset0:128 offset1:129
    v_mfma_f32_16x16x32_bf16 v[44:47], v[64:67], v[128:131], v[44:47]
    ds_read2_b32 v[110:111], v183 offset0:130 offset1:131
    v_mfma_f32_16x16x32_bf16 v[48:51], v[64:67], v[132:135], v[48:51]
    v_mfma_f32_16x16x32_bf16 v[36:39], v[68:71], v[116:119], v[36:39]
    ds_read_b128 v[172:175], v184 offset:3072
    v_mfma_f32_16x16x32_bf16 v[40:43], v[68:71], v[120:123], v[40:43]
    ds_read2_b32 v[112:113], v183 offset0:0 offset1:1
    v_mfma_f32_16x16x32_bf16 v[44:47], v[68:71], v[124:127], v[44:47]
    ds_read2_b32 v[114:115], v183 offset0:2 offset1:3
    v_mfma_f32_16x16x32_bf16 v[48:51], v[68:71], v[128:131], v[48:51]
    ds_read_b128 v[176:179], v184 offset:3584
    v_mfma_f32_16x16x32_bf16 v[40:43], v[72:75], v[116:119], v[40:43]
    v_mfma_f32_16x16x32_bf16 v[44:47], v[72:75], v[120:123], v[44:47]
    v_mfma_f32_16x16x32_bf16 v[48:51], v[72:75], v[124:127], v[48:51]
    v_mfma_f32_16x16x32_bf16 v[44:47], v[76:79], v[116:119], v[44:47]
    v_mfma_f32_16x16x32_bf16 v[48:51], v[76:79], v[120:123], v[48:51]
    v_mfma_f32_16x16x32_bf16 v[48:51], v[80:83], v[116:119], v[48:51]
    s_waitcnt lgkmcnt(0)
    s_cmp_eq_u32 s76, 1
    s_cbranch_scc1 MK_CP29
    s_setprio 0
    s_branch MK_CP29D
MK_CP29:
    s_setprio 1
MK_CP29D:
    v_mfma_f32_16x16x32_bf16 v[20:23], v[84:87], v[148:151], v[20:23]
    v_mfma_f32_16x16x32_bf16 v[24:27], v[84:87], v[152:155], v[24:27]
    v_mfma_f32_16x16x32_bf16 v[28:31], v[84:87], v[156:159], v[28:31]
    v_mfma_f32_16x16x32_bf16 v[32:35], v[84:87], v[160:163], v[32:35]
    v_mfma_f32_16x16x32_bf16 v[36:39], v[84:87], v[164:167], v[36:39]
    v_mfma_f32_16x16x32_bf16 v[40:43], v[84:87], v[168:171], v[40:43]
    v_mfma_f32_16x16x32_bf16 v[44:47], v[84:87], v[172:175], v[44:47]
    v_mfma_f32_16x16x32_bf16 v[48:51], v[84:87], v[176:179], v[48:51]
    v_mfma_f32_16x16x32_bf16 v[24:27], v[88:91], v[148:151], v[24:27]
    v_mfma_f32_16x16x32_bf16 v[28:31], v[88:91], v[152:155], v[28:31]
    v_mfma_f32_16x16x32_bf16 v[32:35], v[88:91], v[156:159], v[32:35]
    v_mfma_f32_16x16x32_bf16 v[36:39], v[88:91], v[160:163], v[36:39]
    v_mfma_f32_16x16x32_bf16 v[40:43], v[88:91], v[164:167], v[40:43]
    v_mfma_f32_16x16x32_bf16 v[44:47], v[88:91], v[168:171], v[44:47]
    v_mfma_f32_16x16x32_bf16 v[48:51], v[88:91], v[172:175], v[48:51]
    v_mfma_f32_16x16x32_bf16 v[28:31], v[92:95], v[148:151], v[28:31]
    v_mfma_f32_16x16x32_bf16 v[32:35], v[92:95], v[152:155], v[32:35]
    v_mfma_f32_16x16x32_bf16 v[36:39], v[92:95], v[156:159], v[36:39]
    v_mfma_f32_16x16x32_bf16 v[40:43], v[92:95], v[160:163], v[40:43]
    v_mfma_f32_16x16x32_bf16 v[44:47], v[92:95], v[164:167], v[44:47]
    v_mfma_f32_16x16x32_bf16 v[48:51], v[92:95], v[168:171], v[48:51]
    v_mfma_f32_16x16x32_bf16 v[32:35], v[96:99], v[148:151], v[32:35]
    v_mfma_f32_16x16x32_bf16 v[36:39], v[96:99], v[152:155], v[36:39]
    v_mfma_f32_16x16x32_bf16 v[40:43], v[96:99], v[156:159], v[40:43]
    v_mfma_f32_16x16x32_bf16 v[44:47], v[96:99], v[160:163], v[44:47]
    v_mfma_f32_16x16x32_bf16 v[48:51], v[96:99], v[164:167], v[48:51]
    v_mfma_f32_16x16x32_bf16 v[36:39], v[100:103], v[148:151], v[36:39]
    s_lshl_b32 s54, s73, 8
    s_add_u32 s54, s54, 13178880
    v_mov_b32 v185, 0
    buffer_load_dword v190, v185, s[60:63], s54 offen sc1
    v_mfma_f32_16x16x32_bf16 v[40:43], v[100:103], v[152:155], v[40:43]
    v_mfma_f32_16x16x32_bf16 v[44:47], v[100:103], v[156:159], v[44:47]
    v_mfma_f32_16x16x32_bf16 v[48:51], v[100:103], v[160:163], v[48:51]
    v_mfma_f32_16x16x32_bf16 v[40:43], v[104:107], v[148:151], v[40:43]
    v_mfma_f32_16x16x32_bf16 v[44:47], v[104:107], v[152:155], v[44:47]
    v_mfma_f32_16x16x32_bf16 v[48:51], v[104:107], v[156:159], v[48:51]
    v_mfma_f32_16x16x32_bf16 v[44:47], v[108:111], v[148:151], v[44:47]
    v_mfma_f32_16x16x32_bf16 v[48:51], v[108:111], v[152:155], v[48:51]
    v_mfma_f32_16x16x32_bf16 v[48:51], v[112:115], v[148:151], v[48:51]
    s_waitcnt lgkmcnt(0)
    s_setprio 0
    s_mov_b32 s53, 0
    s_cmp_ge_u32 s72, 4
    s_cbranch_scc0 MK_NOX01
    s_waitcnt vmcnt(0)
    v_readfirstlane_b32 s77, v190
    s_nop 3
    s_cmp_ge_u32 s77, 16
    s_cbranch_scc0 MK_NOX01
    s_mov_b32 s53, 1
    s_add_u32 s70, s68, 0
    s_and_b32 s70, s70, 15
    s_lshl_b32 s70, s70, 7
    s_add_u32 m0, s3, 122880
    s_add_u32 s77, s70, 0
    buffer_load_dwordx4 v6, s[56:59], s77 offen sc1 lds
    s_add_u32 m0, s3, 123904
    s_add_u32 s77, s70, 0
    buffer_load_dwordx4 v7, s[56:59], s77 offen sc1 lds
    s_add_u32 m0, s3, 124928
    s_add_u32 s77, s70, 32768
    buffer_load_dwordx4 v6, s[56:59], s77 offen sc1 lds
    s_add_u32 m0, s3, 125952
    s_add_u32 s77, s70, 32768
    buffer_load_dwordx4 v7, s[56:59], s77 offen sc1 lds
    s_add_u32 s70, s68, 1
    s_and_b32 s70, s70, 15
    s_lshl_b32 s70, s70, 7
    s_add_u32 m0, s3, 139264
    s_add_u32 s77, s70, 0
    buffer_load_dwordx4 v6, s[56:59], s77 offen sc1 lds
    s_add_u32 m0, s3, 140288
    s_add_u32 s77, s70, 0
    buffer_load_dwordx4 v7, s[56:59], s77 offen sc1 lds
    s_add_u32 m0, s3, 141312
    s_add_u32 s77, s70, 32768
    buffer_load_dwordx4 v6, s[56:59], s77 offen sc1 lds
    s_add_u32 m0, s3, 142336
    s_add_u32 s77, s70, 32768
    buffer_load_dwordx4 v7, s[56:59], s77 offen sc1 lds
MK_NOX01:
    s_nop 7
    s_barrier
    s_lshl_b32 s77, s76, 12
    s_add_u32 s77, s77, s44
    s_add_u32 s77, s77, 4160
    v_lshlrev_b32 v185, 4, v1
    v_add_u32 v185, s77, v185
    s_cmp_eq_u32 s76, 0
    s_cbranch_scc0 MK_C1
    ds_write_b128 v185, v[36:39] offset:0
    ds_write_b128 v185, v[40:43] offset:1024
    ds_write_b128 v185, v[44:47] offset:2048
    ds_write_b128 v185, v[48:51] offset:3072
    s_branch MK_C2
MK_C1:
    ds_write_b128 v185, v[20:23] offset:0
    ds_write_b128 v185, v[24:27] offset:1024
    ds_write_b128 v185, v[28:31] offset:2048
    ds_write_b128 v185, v[32:35] offset:3072
    s_waitcnt lgkmcnt(0)
    v_mov_b32 v20, v36
    v_mov_b32 v21, v37
    v_mov_b32 v22, v38
    v_mov_b32 v23, v39
    v_mov_b32 v24, v40
    v_mov_b32 v25, v41
    v_mov_b32 v26, v42
    v_mov_b32 v27, v43
    v_mov_b32 v28, v44
    v_mov_b32 v29, v45
    v_mov_b32 v30, v46
    v_mov_b32 v31, v47
    v_mov_b32 v32, v48
    v_mov_b32 v33, v49
    v_mov_b32 v34, v50
    v_mov_b32 v35, v51
MK_C2:
    s_waitcnt lgkmcnt(0)
    s_barrier
    s_xor_b32 s77, s76, 1
    s_lshl_b32 s77, s77, 12
    s_add_u32 s77, s77, s44
    s_add_u32 s77, s77, 4160
    v_lshlrev_b32 v185, 4, v1
    v_add_u32 v185, s77, v185
    ds_read_b128 v[52:55], v185 offset:0
    ds_read_b128 v[56:59], v185 offset:1024
    ds_read_b128 v[60:63], v185 offset:2048
    ds_read_b128 v[64:67], v185 offset:3072
    v_and_b32 v186, 15, v1
    v_lshlrev_b32 v186, 5, v186
    v_lshrrev_b32 v187, 4, v1
    v_lshlrev_b32 v187, 3, v187
    v_add_u32 v186, v186, v187
    s_lshl_b32 s77, s76, 11
    s_sub_u32 s77, s44, s77
    s_add_u32 s77, s77, 2552
    v_sub_u32 v187, s77, v186
    ds_read_b64 v[68:69], v187 offset:1536
    ds_read_b64 v[70:71], v187 offset:1024
    ds_read_b64 v[72:73], v187 offset:512
    ds_read_b64 v[74:75], v187 offset:0
    v_lshlrev_b32 v189, 16, v189
    s_waitcnt lgkmcnt(0)
    v_add_f32 v20, v20, v52
    v_add_f32 v21, v21, v53
    v_add_f32 v22, v22, v54
    v_add_f32 v23, v23, v55
    v_and_b32 v185, 0xffff0000, v69
    v_fmac_f32 v20, v185, v189
    v_lshlrev_b32 v185, 16, v69
    v_fmac_f32 v21, v185, v189
    v_and_b32 v185, 0xffff0000, v68
    v_fmac_f32 v22, v185, v189
    v_lshlrev_b32 v185, 16, v68
    v_fmac_f32 v23, v185, v189
    v_cvt_pk_bf16_f32 v76, v20, v21
    v_cvt_pk_bf16_f32 v77, v22, v23
    v_add_f32 v24, v24, v56
    v_add_f32 v25, v25, v57
    v_add_f32 v26, v26, v58
    v_add_f32 v27, v27, v59
    v_and_b32 v185, 0xffff0000, v71
    v_fmac_f32 v24, v185, v189
    v_lshlrev_b32 v185, 16, v71
    v_fmac_f32 v25, v185, v189
    v_and_b32 v185, 0xffff0000, v70
    v_fmac_f32 v26, v185, v189
    v_lshlrev_b32 v185, 16, v70
    v_fmac_f32 v27, v185, v189
    v_cvt_pk_bf16_f32 v78, v24, v25
    v_cvt_pk_bf16_f32 v79, v26, v27
    v_add_f32 v28, v28, v60
    v_add_f32 v29, v29, v61
    v_add_f32 v30, v30, v62
    v_add_f32 v31, v31, v63
    v_and_b32 v185, 0xffff0000, v73
    v_fmac_f32 v28, v185, v189
    v_lshlrev_b32 v185, 16, v73
    v_fmac_f32 v29, v185, v189
    v_and_b32 v185, 0xffff0000, v72
    v_fmac_f32 v30, v185, v189
    v_lshlrev_b32 v185, 16, v72
    v_fmac_f32 v31, v185, v189
    v_cvt_pk_bf16_f32 v80, v28, v29
    v_cvt_pk_bf16_f32 v81, v30, v31
    v_add_f32 v32, v32, v64
    v_add_f32 v33, v33, v65
    v_add_f32 v34, v34, v66
    v_add_f32 v35, v35, v67
    v_and_b32 v185, 0xffff0000, v75
    v_fmac_f32 v32, v185, v189
    v_lshlrev_b32 v185, 16, v75
    v_fmac_f32 v33, v185, v189
    v_and_b32 v185, 0xffff0000, v74
    v_fmac_f32 v34, v185, v189
    v_lshlrev_b32 v185, 16, v74
    v_fmac_f32 v35, v185, v189
    v_cvt_pk_bf16_f32 v82, v32, v33
    v_cvt_pk_bf16_f32 v83, v34, v35
    s_lshl_b32 s77, s2, 2
    s_add_u32 s77, s77, s75
    s_lshl_b32 s77, s77, 12
    s_lshl_b32 s78, s76, 11
    s_add_u32 s77, s77, s78
    s_add_u32 s77, s77, 8650752
    buffer_store_dwordx2 v[76:77], v186, s[60:63], s77 offen offset:0 sc1
    buffer_store_dwordx2 v[78:79], v186, s[60:63], s77 offen offset:512 sc1
    buffer_store_dwordx2 v[80:81], v186, s[60:63], s77 offen offset:1024 sc1
    buffer_store_dwordx2 v[82:83], v186, s[60:63], s77 offen offset:1536 sc1
    s_barrier
    s_cmp_ge_u32 s72, 4
    s_cbranch_scc0 MK_P3C
    s_cmp_eq_u32 s53, 1
    s_cbranch_scc1 MK_XE1
    v_lshlrev_b32 v2, 2, v1
    s_mov_b32 exec_lo, 0x1
    s_mov_b32 exec_hi, 0
    s_mov_b32 s78, 0x20000
MK_POLL30:
    buffer_load_dword v3, v2, s[60:63], s54 offen sc1
    s_waitcnt vmcnt(0)
    v_cmp_gt_u32 vcc, 16, v3
    s_cbranch_vccz MK_POLL30D
    s_sleep 1
    s_sub_u32 s78, s78, 1
    s_cmp_lg_u32 s78, 0
    s_cbranch_scc1 MK_POLL30
MK_POLL30D:
    s_mov_b64 exec, -1
    s_add_u32 s70, s68, 0
    s_and_b32 s70, s70, 15
    s_lshl_b32 s70, s70, 7
    s_add_u32 m0, s3, 122880
    s_add_u32 s77, s70, 0
    buffer_load_dwordx4 v6, s[56:59], s77 offen sc1 lds
    s_add_u32 m0, s3, 123904
    s_add_u32 s77, s70, 0
    buffer_load_dwordx4 v7, s[56:59], s77 offen sc1 lds
    s_add_u32 m0, s3, 124928
    s_add_u32 s77, s70, 32768
    buffer_load_dwordx4 v6, s[56:59], s77 offen sc1 lds
    s_add_u32 m0, s3, 125952
    s_add_u32 s77, s70, 32768
    buffer_load_dwordx4 v7, s[56:59], s77 offen sc1 lds
    s_add_u32 s70, s68, 1
    s_and_b32 s70, s70, 15
    s_lshl_b32 s70, s70, 7
    s_add_u32 m0, s3, 139264
    s_add_u32 s77, s70, 0
    buffer_load_dwordx4 v6, s[56:59], s77 offen sc1 lds
    s_add_u32 m0, s3, 140288
    s_add_u32 s77, s70, 0
    buffer_load_dwordx4 v7, s[56:59], s77 offen sc1 lds
    s_add_u32 m0, s3, 141312
    s_add_u32 s77, s70, 32768
    buffer_load_dwordx4 v6, s[56:59], s77 offen sc1 lds
    s_add_u32 m0, s3, 142336
    s_add_u32 s77, s70, 32768
    buffer_load_dwordx4 v7, s[56:59], s77 offen sc1 lds
MK_XE1:
    s_add_u32 s70, s68, 2
    s_and_b32 s70, s70, 15
    s_lshl_b32 s70, s70, 7
    s_add_u32 m0, s3, 0
    s_add_u32 s77, s70, 0
    buffer_load_dwordx4 v6, s[56:59], s77 offen sc1 lds
    s_add_u32 m0, s3, 1024
    s_add_u32 s77, s70, 0
    buffer_load_dwordx4 v7, s[56:59], s77 offen sc1 lds
    s_add_u32 m0, s3, 2048
    s_add_u32 s77, s70, 32768
    buffer_load_dwordx4 v6, s[56:59], s77 offen sc1 lds
    s_add_u32 m0, s3, 3072
    s_add_u32 s77, s70, 32768
    buffer_load_dwordx4 v7, s[56:59], s77 offen sc1 lds
    s_add_u32 s70, s68, 3
    s_and_b32 s70, s70, 15
    s_lshl_b32 s70, s70, 7
    s_add_u32 m0, s3, 16384
    s_add_u32 s77, s70, 0
    buffer_load_dwordx4 v6, s[56:59], s77 offen sc1 lds
    s_add_u32 m0, s3, 17408
    s_add_u32 s77, s70, 0
    buffer_load_dwordx4 v7, s[56:59], s77 offen sc1 lds
    s_add_u32 m0, s3, 18432
    s_add_u32 s77, s70, 32768
    buffer_load_dwordx4 v6, s[56:59], s77 offen sc1 lds
    s_add_u32 m0, s3, 19456
    s_add_u32 s77, s70, 32768
    buffer_load_dwordx4 v7, s[56:59], s77 offen sc1 lds
    s_add_u32 s70, s68, 4
    s_and_b32 s70, s70, 15
    s_lshl_b32 s70, s70, 7
    s_add_u32 m0, s3, 32768
    s_add_u32 s77, s70, 0
    buffer_load_dwordx4 v6, s[56:59], s77 offen sc1 lds
    s_add_u32 m0, s3, 33792
    s_add_u32 s77, s70, 0
    buffer_load_dwordx4 v7, s[56:59], s77 offen sc1 lds
    s_add_u32 m0, s3, 34816
    s_add_u32 s77, s70, 32768
    buffer_load_dwordx4 v6, s[56:59], s77 offen sc1 lds
    s_add_u32 m0, s3, 35840
    s_add_u32 s77, s70, 32768
    buffer_load_dwordx4 v7, s[56:59], s77 offen sc1 lds
    s_lshl_b32 s77, s74, 6
    s_lshl_b32 s78, s75, 4
    s_add_u32 s77, s77, s78
    v_lshrrev_b32 v2, 4, v1
    v_add_u32 v2, s77, v2
    v_lshlrev_b32 v2, 12, v2
    v_and_b32 v3, 15, v1
    v_lshlrev_b32 v3, 4, v3
    v_add_u32 v2, v2, v3
    s_lshl_b32 s77, s73, 8
    v_add_u32 v9, s77, v2
    s_waitcnt vmcnt(12)
    s_barrier
    s_cmp_eq_u32 s72, 4
    s_cbranch_scc0 MK_NOARRZ
    s_lshr_b32 s79, s2, 4
    s_add_u32 s79, s79, 40
    s_lshl_b32 s77, s79, 8
    s_add_u32 s77, s77, 13172736
    v_mov_b32 v2, 0
    v_mov_b32 v3, 1
    s_mov_b32 exec_lo, 0x1
    s_mov_b32 exec_hi, 0
    buffer_atomic_add v3, v2, s[60:63], s77 offen sc1
    s_mov_b64 exec, -1
MK_NOARRZ:
    s_waitcnt vmcnt(12)
    s_barrier
    s_add_u32 s70, s68, 5
    s_and_b32 s70, s70, 15
    s_lshl_b32 s70, s70, 7
    s_add_u32 m0, s3, 122880
    s_add_u32 s77, s70, 0
    buffer_load_dwordx4 v6, s[56:59], s77 offen sc1 lds
    s_add_u32 m0, s3, 123904
    s_add_u32 s77, s70, 0
    buffer_load_dwordx4 v7, s[56:59], s77 offen sc1 lds
    s_add_u32 m0, s3, 124928
    s_add_u32 s77, s70, 32768
    buffer_load_dwordx4 v6, s[56:59], s77 offen sc1 lds
    s_add_u32 m0, s3, 125952
    s_add_u32 s77, s70, 32768
    buffer_load_dwordx4 v7, s[56:59], s77 offen sc1 lds
    s_add_u32 s71, s68, 8
    s_and_b32 s71, s71, 15
    s_lshl_b32 s71, s71, 17
    s_lshr_b32 s78, s3, 1
    s_add_u32 m0, s78, 53248
    s_add_u32 s78, s71, 0
    buffer_load_dwordx4 v8, s[36:39], s78 offen lds
    s_lshr_b32 s78, s3, 1
    s_add_u32 m0, s78, 54272
    s_add_u32 s78, s71, 16384
    buffer_load_dwordx4 v8, s[36:39], s78 offen lds
    s_waitcnt vmcnt(14)
    s_barrier
    s_add_u32 s70, s68, 6
    s_and_b32 s70, s70, 15
    s_lshl_b32 s70, s70, 7
    s_add_u32 m0, s3, 139264
    s_add_u32 s77, s70, 0
    buffer_load_dwordx4 v6, s[56:59], s77 offen sc1 lds
    s_add_u32 m0, s3, 140288
    s_add_u32 s77, s70, 0
    buffer_load_dwordx4 v7, s[56:59], s77 offen sc1 lds
    s_add_u32 m0, s3, 141312
    s_add_u32 s77, s70, 32768
    buffer_load_dwordx4 v6, s[56:59], s77 offen sc1 lds
    s_add_u32 m0, s3, 142336
    s_add_u32 s77, s70, 32768
    buffer_load_dwordx4 v7, s[56:59], s77 offen sc1 lds
    s_add_u32 s71, s68, 9
    s_and_b32 s71, s71, 15
    s_lshl_b32 s71, s71, 17
    s_lshr_b32 s78, s3, 1
    s_add_u32 m0, s78, 61440
    s_add_u32 s78, s71, 0
    buffer_load_dwordx4 v8, s[36:39], s78 offen lds
    s_lshr_b32 s78, s3, 1
    s_add_u32 m0, s78, 62464
    s_add_u32 s78, s71, 16384
    buffer_load_dwordx4 v8, s[36:39], s78 offen lds
    s_waitcnt vmcnt(16)
    s_barrier
    s_add_u32 s70, s68, 7
    s_and_b32 s70, s70, 15
    s_lshl_b32 s70, s70, 7
    s_add_u32 m0, s3, 0
    s_add_u32 s77, s70, 0
    buffer_load_dwordx4 v6, s[56:59], s77 offen sc1 lds
    s_add_u32 m0, s3, 1024
    s_add_u32 s77, s70, 0
    buffer_load_dwordx4 v7, s[56:59], s77 offen sc1 lds
    s_add_u32 m0, s3, 2048
    s_add_u32 s77, s70, 32768
    buffer_load_dwordx4 v6, s[56:59], s77 offen sc1 lds
    s_add_u32 m0, s3, 3072
    s_add_u32 s77, s70, 32768
    buffer_load_dwordx4 v7, s[56:59], s77 offen sc1 lds
    s_add_u32 s71, s68, 10
    s_and_b32 s71, s71, 15
    s_lshl_b32 s71, s71, 17
    s_lshr_b32 s78, s3, 1
    s_add_u32 m0, s78, 69632
    s_add_u32 s78, s71, 0
    buffer_load_dwordx4 v8, s[36:39], s78 offen lds
    s_lshr_b32 s78, s3, 1
    s_add_u32 m0, s78, 70656
    s_add_u32 s78, s71, 16384
    buffer_load_dwordx4 v8, s[36:39], s78 offen lds
    s_waitcnt vmcnt(18)
    s_barrier
    s_add_u32 s70, s68, 8
    s_and_b32 s70, s70, 15
    s_lshl_b32 s70, s70, 7
    s_add_u32 m0, s3, 16384
    s_add_u32 s77, s70, 0
    buffer_load_dwordx4 v6, s[56:59], s77 offen sc1 lds
    s_add_u32 m0, s3, 17408
    s_add_u32 s77, s70, 0
    buffer_load_dwordx4 v7, s[56:59], s77 offen sc1 lds
    s_add_u32 m0, s3, 18432
    s_add_u32 s77, s70, 32768
    buffer_load_dwordx4 v6, s[56:59], s77 offen sc1 lds
    s_add_u32 m0, s3, 19456
    s_add_u32 s77, s70, 32768
    buffer_load_dwordx4 v7, s[56:59], s77 offen sc1 lds
    s_add_u32 s71, s68, 11
    s_and_b32 s71, s71, 15
    s_lshl_b32 s71, s71, 17
    s_lshr_b32 s78, s3, 1
    s_add_u32 m0, s78, 77824
    s_add_u32 s78, s71, 0
    buffer_load_dwordx4 v8, s[36:39], s78 offen lds
    s_lshr_b32 s78, s3, 1
    s_add_u32 m0, s78, 78848
    s_add_u32 s78, s71, 16384
    buffer_load_dwordx4 v8, s[36:39], s78 offen lds
    s_waitcnt vmcnt(20)
    s_barrier
    s_add_u32 s70, s68, 9
    s_and_b32 s70, s70, 15
    s_lshl_b32 s70, s70, 7
    s_add_u32 m0, s3, 32768
    s_add_u32 s77, s70, 0
    buffer_load_dwordx4 v6, s[56:59], s77 offen sc1 lds
    s_add_u32 m0, s3, 33792
    s_add_u32 s77, s70, 0
    buffer_load_dwordx4 v7, s[56:59], s77 offen sc1 lds
    s_add_u32 m0, s3, 34816
    s_add_u32 s77, s70, 32768
    buffer_load_dwordx4 v6, s[56:59], s77 offen sc1 lds
    s_add_u32 m0, s3, 35840
    s_add_u32 s77, s70, 32768
    buffer_load_dwordx4 v7, s[56:59], s77 offen sc1 lds
    s_add_u32 s71, s68, 12
    s_and_b32 s71, s71, 15
    s_lshl_b32 s71, s71, 17
    s_lshr_b32 s78, s3, 1
    s_add_u32 m0, s78, 86016
    s_add_u32 s78, s71, 0
    buffer_load_dwordx4 v8, s[36:39], s78 offen lds
    s_lshr_b32 s78, s3, 1
    s_add_u32 m0, s78, 87040
    s_add_u32 s78, s71, 16384
    buffer_load_dwordx4 v8, s[36:39], s78 offen lds
    s_waitcnt vmcnt(20)
    s_barrier
    s_add_u32 s70, s68, 10
    s_and_b32 s70, s70, 15
    s_lshl_b32 s70, s70, 7
    s_add_u32 m0, s3, 122880
    s_add_u32 s77, s70, 0
    buffer_load_dwordx4 v6, s[56:59], s77 offen sc1 lds
    s_add_u32 m0, s3, 123904
    s_add_u32 s77, s70, 0
    buffer_load_dwordx4 v7, s[56:59], s77 offen sc1 lds
    s_add_u32 m0, s3, 124928
    s_add_u32 s77, s70, 32768
    buffer_load_dwordx4 v6, s[56:59], s77 offen sc1 lds
    s_add_u32 m0, s3, 125952
    s_add_u32 s77, s70, 32768
    buffer_load_dwordx4 v7, s[56:59], s77 offen sc1 lds
    s_add_u32 s71, s68, 13
    s_and_b32 s71, s71, 15
    s_lshl_b32 s71, s71, 17
    s_lshr_b32 s78, s3, 1
    s_add_u32 m0, s78, 94208
    s_add_u32 s78, s71, 0
    buffer_load_dwordx4 v8, s[36:39], s78 offen lds
    s_lshr_b32 s78, s3, 1
    s_add_u32 m0, s78, 95232
    s_add_u32 s78, s71, 16384
    buffer_load_dwordx4 v8, s[36:39], s78 offen lds
    s_waitcnt vmcnt(20)
    s_barrier
    s_add_u32 s70, s68, 11
    s_and_b32 s70, s70, 15
    s_lshl_b32 s70, s70, 7
    s_add_u32 m0, s3, 139264
    s_add_u32 s77, s70, 0
    buffer_load_dwordx4 v6, s[56:59], s77 offen sc1 lds
    s_add_u32 m0, s3, 140288
    s_add_u32 s77, s70, 0
    buffer_load_dwordx4 v7, s[56:59], s77 offen sc1 lds
    s_add_u32 m0, s3, 141312
    s_add_u32 s77, s70, 32768
    buffer_load_dwordx4 v6, s[56:59], s77 offen sc1 lds
    s_add_u32 m0, s3, 142336
    s_add_u32 s77, s70, 32768
    buffer_load_dwordx4 v7, s[56:59], s77 offen sc1 lds
    s_add_u32 s71, s68, 14
    s_and_b32 s71, s71, 15
    s_lshl_b32 s71, s71, 17
    s_lshr_b32 s78, s3, 1
    s_add_u32 m0, s78, 102400
    s_add_u32 s78, s71, 0
    buffer_load_dwordx4 v8, s[36:39], s78 offen lds
    s_lshr_b32 s78, s3, 1
    s_add_u32 m0, s78, 103424
    s_add_u32 s78, s71, 16384
    buffer_load_dwordx4 v8, s[36:39], s78 offen lds
    s_waitcnt vmcnt(20)
    s_barrier
    s_add_u32 s70, s68, 12
    s_and_b32 s70, s70, 15
    s_lshl_b32 s70, s70, 7
    s_add_u32 m0, s3, 0
    s_add_u32 s77, s70, 0
    buffer_load_dwordx4 v6, s[56:59], s77 offen sc1 lds
    s_add_u32 m0, s3, 1024
    s_add_u32 s77, s70, 0
    buffer_load_dwordx4 v7, s[56:59], s77 offen sc1 lds
    s_add_u32 m0, s3, 2048
    s_add_u32 s77, s70, 32768
    buffer_load_dwordx4 v6, s[56:59], s77 offen sc1 lds
    s_add_u32 m0, s3, 3072
    s_add_u32 s77, s70, 32768
    buffer_load_dwordx4 v7, s[56:59], s77 offen sc1 lds
    s_add_u32 s71, s68, 15
    s_and_b32 s71, s71, 15
    s_lshl_b32 s71, s71, 17
    s_lshr_b32 s78, s3, 1
    s_add_u32 m0, s78, 110592
    s_add_u32 s78, s71, 0
    buffer_load_dwordx4 v8, s[36:39], s78 offen lds
    s_lshr_b32 s78, s3, 1
    s_add_u32 m0, s78, 111616
    s_add_u32 s78, s71, 16384
    buffer_load_dwordx4 v8, s[36:39], s78 offen lds
    s_waitcnt vmcnt(20)
    s_barrier
    s_add_u32 s70, s68, 13
    s_and_b32 s70, s70, 15
    s_lshl_b32 s70, s70, 7
    s_add_u32 m0, s3, 16384
    s_add_u32 s77, s70, 0
    buffer_load_dwordx4 v6, s[56:59], s77 offen sc1 lds
    s_add_u32 m0, s3, 17408
    s_add_u32 s77, s70, 0
    buffer_load_dwordx4 v7, s[56:59], s77 offen sc1 lds
    s_add_u32 m0, s3, 18432
    s_add_u32 s77, s70, 32768
    buffer_load_dwordx4 v6, s[56:59], s77 offen sc1 lds
    s_add_u32 m0, s3, 19456
    s_add_u32 s77, s70, 32768
    buffer_load_dwordx4 v7, s[56:59], s77 offen sc1 lds
    s_lshl_b32 s54, s74, 8
    s_add_u32 s54, s54, 13182976
    v_mov_b32 v2, 0
    buffer_load_dword v10, v2, s[60:63], s54 offen sc1
    s_waitcnt vmcnt(19)
    s_barrier
    s_add_u32 s70, s68, 14
    s_and_b32 s70, s70, 15
    s_lshl_b32 s70, s70, 7
    s_add_u32 m0, s3, 32768
    s_add_u32 s77, s70, 0
    buffer_load_dwordx4 v6, s[56:59], s77 offen sc1 lds
    s_add_u32 m0, s3, 33792
    s_add_u32 s77, s70, 0
    buffer_load_dwordx4 v7, s[56:59], s77 offen sc1 lds
    s_add_u32 m0, s3, 34816
    s_add_u32 s77, s70, 32768
    buffer_load_dwordx4 v6, s[56:59], s77 offen sc1 lds
    s_add_u32 m0, s3, 35840
    s_add_u32 s77, s70, 32768
    buffer_load_dwordx4 v7, s[56:59], s77 offen sc1 lds
    s_waitcnt vmcnt(17)
    s_barrier
    s_add_u32 s70, s68, 15
    s_and_b32 s70, s70, 15
    s_lshl_b32 s70, s70, 7
    s_add_u32 m0, s3, 122880
    s_add_u32 s77, s70, 0
    buffer_load_dwordx4 v6, s[56:59], s77 offen sc1 lds
    s_add_u32 m0, s3, 123904
    s_add_u32 s77, s70, 0
    buffer_load_dwordx4 v7, s[56:59], s77 offen sc1 lds
    s_add_u32 m0, s3, 124928
    s_add_u32 s77, s70, 32768
    buffer_load_dwordx4 v6, s[56:59], s77 offen sc1 lds
    s_add_u32 m0, s3, 125952
    s_add_u32 s77, s70, 32768
    buffer_load_dwordx4 v7, s[56:59], s77 offen sc1 lds
    s_waitcnt vmcnt(15)
    s_barrier
    s_waitcnt vmcnt(8)
    v_readfirstlane_b32 s77, v10
    s_nop 3
    s_cmp_ge_u32 s77, 16
    s_cbranch_scc1 MK_ZOK
    v_lshlrev_b32 v2, 2, v1
    s_mov_b32 exec_lo, 0x1
    s_mov_b32 exec_hi, 0
    s_mov_b32 s78, 0x20000
MK_POLL31:
    buffer_load_dword v3, v2, s[60:63], s54 offen sc1
    s_waitcnt vmcnt(0)
    v_cmp_gt_u32 vcc, 16, v3
    s_cbranch_vccz MK_POLL31D
    s_sleep 1
    s_sub_u32 s78, s78, 1
    s_cmp_lg_u32 s78, 0
    s_cbranch_scc1 MK_POLL31
MK_POLL31D:
    s_mov_b64 exec, -1
MK_ZOK:
    s_add_u32 m0, s3, 53248
    s_mov_b32 s78, 8650752
    buffer_load_dwordx4 v9, s[60:63], s78 offen sc1 lds
    s_add_u32 m0, s3, 54272
    s_mov_b32 s78, 8667136
    buffer_load_dwordx4 v9, s[60:63], s78 offen sc1 lds
    s_add_u32 m0, s3, 55296
    s_mov_b32 s78, 8683520
    buffer_load_dwordx4 v9, s[60:63], s78 offen sc1 lds
    s_add_u32 m0, s3, 56320
    s_mov_b32 s78, 8699904
    buffer_load_dwordx4 v9, s[60:63], s78 offen sc1 lds
    s_waitcnt vmcnt(13)
    s_barrier
    s_waitcnt vmcnt(8)
    s_barrier
    s_waitcnt vmcnt(0)
    s_barrier
    s_branch MK_FIN
MK_P3C:
    s_waitcnt vmcnt(0)
    v_and_b32 v2, 31, v1
    v_lshrrev_b32 v3, 1, v2
    v_and_b32 v3, 7, v3
    v_lshrrev_b32 v4, 5, v1
    v_xor_b32 v3, v3, v4
    v_lshlrev_b32 v3, 4, v3
    s_lshl_b32 s77, s75, 5
    v_add_u32 v2, s77, v2
    v_lshlrev_b32 v2, 7, v2
    v_add_u32 v2, v2, v3
    v_mov_b32 v10, v2
    v_xor_b32 v11, 32, v10
    v_xor_b32 v12, 64, v10
    v_xor_b32 v13, 96, v10
    v_add_u32 v204, 65536, v10
    v_add_u32 v205, 65536, v11
    v_add_u32 v206, 65536, v12
    v_add_u32 v207, 65536, v13
    v_add_u32 v208, 131072, v10
    v_add_u32 v209, 131072, v11
    v_add_u32 v210, 131072, v12
    v_add_u32 v211, 131072, v13
    v_and_b32 v2, 15, v1
    v_lshrrev_b32 v3, 5, v1
    v_lshlrev_b32 v3, 3, v3
    v_lshrrev_b32 v4, 2, v2
    v_add_u32 v3, v3, v4
    v_lshlrev_b32 v3, 7, v3
    v_bfe_u32 v4, v1, 4, 1
    v_lshlrev_b32 v4, 1, v4
    v_bfe_u32 v5, v2, 1, 1
    v_add_u32 v4, v4, v5
    v_bfe_u32 v5, v2, 3, 1
    v_lshlrev_b32 v5, 2, v5
    v_xor_b32 v4, v4, v5
    v_lshlrev_b32 v4, 4, v4
    v_add_u32 v3, v3, v4
    v_and_b32 v4, 1, v2
    v_lshlrev_b32 v4, 3, v4
    v_add_u32 v3, v3, v4
    v_mov_b32 v14, v3
    v_xor_b32 v15, 64, v14
    v_add_u32 v212, 61440, v14
    v_add_u32 v213, 61440, v15
    v_add_u32 v214, 122880, v14
    v_add_u32 v215, 122880, v15
    s_lshl_b32 s77, s73, 7
    s_lshl_b32 s78, s75, 5
    s_add_u32 s77, s77, s78
    v_and_b32 v2, 31, v1
    v_add_u32 v2, s77, v2
    v_lshlrev_b32 v2, 3, v2
    s_mov_b32 s77, 13107200
    buffer_load_dwordx2 v[238:239], v2, s[60:63], s77 offen sc1
    s_mov_b32 s56, s26
    s_mov_b32 s57, s27
    s_mov_b32 s58, 0x400000
    s_mov_b32 s59, 0x20000
    v_and_b32 v2, 15, v1
    v_lshrrev_b32 v3, 2, v2
    v_lshrrev_b32 v4, 5, v1
    v_lshlrev_b32 v4, 2, v4
    v_add_u32 v3, v3, v4
    v_lshlrev_b32 v3, 8, v3
    v_and_b32 v2, 3, v2
    v_lshlrev_b32 v2, 3, v2
    v_add_u32 v3, v3, v2
    v_bfe_u32 v2, v1, 4, 1
    v_lshlrev_b32 v2, 5, v2
    v_add_u32 v3, v3, v2
    s_lshl_b32 s77, s75, 6
    s_add_u32 s77, s77, 53248
    v_add_u32 v16, s77, v3
    s_lshl_b32 s77, s73, 7
    s_lshl_b32 s78, s75, 5
    s_add_u32 s77, s77, s78
    v_and_b32 v2, 31, v1
    v_add_u32 v2, s77, v2
    v_lshlrev_b32 v2, 11, v2
    s_lshl_b32 s77, s74, 7
    v_add_u32 v2, s77, v2
    v_lshrrev_b32 v3, 5, v1
    v_lshlrev_b32 v3, 4, v3
    v_add_u32 v17, v2, v3
    s_barrier
    ds_read_b128 v[52:55], v204 offset:57344
    ds_read_b64_tr_b16 v[56:57], v14 offset:53248
    ds_read_b64_tr_b16 v[58:59], v14 offset:53760
    ds_read_b64_tr_b16 v[60:61], v15 offset:53248
    ds_read_b64_tr_b16 v[62:63], v15 offset:53760
    ds_read_b128 v[64:67], v205 offset:57344
    ds_read_b64_tr_b16 v[68:69], v14 offset:55296
    ds_read_b64_tr_b16 v[70:71], v14 offset:55808
    ds_read_b64_tr_b16 v[72:73], v15 offset:55296
    ds_read_b64_tr_b16 v[74:75], v15 offset:55808
    ds_read_b128 v[76:79], v206 offset:57344
    ds_read_b64_tr_b16 v[80:81], v14 offset:57344
    ds_read_b64_tr_b16 v[82:83], v14 offset:57856
    ds_read_b64_tr_b16 v[84:85], v15 offset:57344
    ds_read_b64_tr_b16 v[86:87], v15 offset:57856
    ds_read_b128 v[88:91], v207 offset:57344
    ds_read_b64_tr_b16 v[92:93], v14 offset:59392
    ds_read_b64_tr_b16 v[94:95], v14 offset:59904
    ds_read_b64_tr_b16 v[96:97], v15 offset:59392
    ds_read_b64_tr_b16 v[98:99], v15 offset:59904
    s_waitcnt lgkmcnt(0)
    s_barrier
    v_mfma_f32_32x32x16_bf16 v[20:35], v[56:59], v[52:55], 0
    ds_read_b128 v[100:103], v208 offset:8192
    ds_read_b64_tr_b16 v[104:105], v212 offset:0
    ds_read_b64_tr_b16 v[106:107], v212 offset:512
    ds_read_b64_tr_b16 v[108:109], v213 offset:0
    v_mfma_f32_32x32x16_bf16 v[36:51], v[60:63], v[52:55], 0
    ds_read_b64_tr_b16 v[110:111], v213 offset:512
    ds_read_b128 v[112:115], v209 offset:8192
    ds_read_b64_tr_b16 v[116:117], v212 offset:2048
    ds_read_b64_tr_b16 v[118:119], v212 offset:2560
    v_mfma_f32_32x32x16_bf16 v[20:35], v[68:71], v[64:67], v[20:35]
    ds_read_b64_tr_b16 v[120:121], v213 offset:2048
    ds_read_b64_tr_b16 v[122:123], v213 offset:2560
    ds_read_b128 v[124:127], v210 offset:8192
    ds_read_b64_tr_b16 v[128:129], v212 offset:4096
    v_mfma_f32_32x32x16_bf16 v[36:51], v[72:75], v[64:67], v[36:51]
    ds_read_b64_tr_b16 v[130:131], v212 offset:4608
    ds_read_b64_tr_b16 v[132:133], v213 offset:4096
    ds_read_b64_tr_b16 v[134:135], v213 offset:4608
    ds_read_b128 v[136:139], v211 offset:8192
    v_mfma_f32_32x32x16_bf16 v[20:35], v[80:83], v[76:79], v[20:35]
    ds_read_b64_tr_b16 v[140:141], v212 offset:6144
    ds_read_b64_tr_b16 v[142:143], v212 offset:6656
    ds_read_b64_tr_b16 v[144:145], v213 offset:6144
    ds_read_b64_tr_b16 v[146:147], v213 offset:6656
    v_mfma_f32_32x32x16_bf16 v[36:51], v[84:87], v[76:79], v[36:51]
    v_mfma_f32_32x32x16_bf16 v[20:35], v[92:95], v[88:91], v[20:35]
    v_mfma_f32_32x32x16_bf16 v[36:51], v[96:99], v[88:91], v[36:51]
    s_waitcnt lgkmcnt(0)
    s_barrier
    v_mfma_f32_32x32x16_bf16 v[20:35], v[104:107], v[100:103], v[20:35]
    ds_read_b128 v[52:55], v10 offset:0
    ds_read_b64_tr_b16 v[56:57], v212 offset:8192
    ds_read_b64_tr_b16 v[58:59], v212 offset:8704
    ds_read_b64_tr_b16 v[60:61], v213 offset:8192
    v_mfma_f32_32x32x16_bf16 v[36:51], v[108:111], v[100:103], v[36:51]
    ds_read_b64_tr_b16 v[62:63], v213 offset:8704
    ds_read_b128 v[64:67], v11 offset:0
    ds_read_b64_tr_b16 v[68:69], v212 offset:10240
    ds_read_b64_tr_b16 v[70:71], v212 offset:10752
    v_mfma_f32_32x32x16_bf16 v[20:35], v[116:119], v[112:115], v[20:35]
    ds_read_b64_tr_b16 v[72:73], v213 offset:10240
    ds_read_b64_tr_b16 v[74:75], v213 offset:10752
    ds_read_b128 v[76:79], v12 offset:0
    ds_read_b64_tr_b16 v[80:81], v212 offset:12288
    v_mfma_f32_32x32x16_bf16 v[36:51], v[120:123], v[112:115], v[36:51]
    ds_read_b64_tr_b16 v[82:83], v212 offset:12800
    ds_read_b64_tr_b16 v[84:85], v213 offset:12288
    ds_read_b64_tr_b16 v[86:87], v213 offset:12800
    ds_read_b128 v[88:91], v13 offset:0
    v_mfma_f32_32x32x16_bf16 v[20:35], v[128:131], v[124:127], v[20:35]
    ds_read_b64_tr_b16 v[92:93], v212 offset:14336
    ds_read_b64_tr_b16 v[94:95], v212 offset:14848
    ds_read_b64_tr_b16 v[96:97], v213 offset:14336
    ds_read_b64_tr_b16 v[98:99], v213 offset:14848
    v_mfma_f32_32x32x16_bf16 v[36:51], v[132:135], v[124:127], v[36:51]
    v_mfma_f32_32x32x16_bf16 v[20:35], v[140:143], v[136:139], v[20:35]
    v_mfma_f32_32x32x16_bf16 v[36:51], v[144:147], v[136:139], v[36:51]
    s_waitcnt lgkmcnt(0)
    s_barrier
    v_mfma_f32_32x32x16_bf16 v[20:35], v[56:59], v[52:55], v[20:35]
    ds_read_b128 v[100:103], v10 offset:16384
    ds_read_b64_tr_b16 v[104:105], v212 offset:16384
    ds_read_b64_tr_b16 v[106:107], v212 offset:16896
    ds_read_b64_tr_b16 v[108:109], v213 offset:16384
    v_mfma_f32_32x32x16_bf16 v[36:51], v[60:63], v[52:55], v[36:51]
    ds_read_b64_tr_b16 v[110:111], v213 offset:16896
    ds_read_b128 v[112:115], v11 offset:16384
    ds_read_b64_tr_b16 v[116:117], v212 offset:18432
    ds_read_b64_tr_b16 v[118:119], v212 offset:18944
    v_mfma_f32_32x32x16_bf16 v[20:35], v[68:71], v[64:67], v[20:35]
    ds_read_b64_tr_b16 v[120:121], v213 offset:18432
    ds_read_b64_tr_b16 v[122:123], v213 offset:18944
    ds_read_b128 v[124:127], v12 offset:16384
    ds_read_b64_tr_b16 v[128:129], v212 offset:20480
    v_mfma_f32_32x32x16_bf16 v[36:51], v[72:75], v[64:67], v[36:51]
    ds_read_b64_tr_b16 v[130:131], v212 offset:20992
    ds_read_b64_tr_b16 v[132:133], v213 offset:20480
    ds_read_b64_tr_b16 v[134:135], v213 offset:20992
    ds_read_b128 v[136:139], v13 offset:16384
    v_mfma_f32_32x32x16_bf16 v[20:35], v[80:83], v[76:79], v[20:35]
    ds_read_b64_tr_b16 v[140:141], v212 offset:22528
    ds_read_b64_tr_b16 v[142:143], v212 offset:23040
    ds_read_b64_tr_b16 v[144:145], v213 offset:22528
    ds_read_b64_tr_b16 v[146:147], v213 offset:23040
    v_mfma_f32_32x32x16_bf16 v[36:51], v[84:87], v[76:79], v[36:51]
    v_mfma_f32_32x32x16_bf16 v[20:35], v[92:95], v[88:91], v[20:35]
    v_mfma_f32_32x32x16_bf16 v[36:51], v[96:99], v[88:91], v[36:51]
    s_waitcnt lgkmcnt(0)
    s_barrier
    v_mfma_f32_32x32x16_bf16 v[20:35], v[104:107], v[100:103], v[20:35]
    ds_read_b128 v[52:55], v10 offset:32768
    ds_read_b64_tr_b16 v[56:57], v212 offset:24576
    ds_read_b64_tr_b16 v[58:59], v212 offset:25088
    ds_read_b64_tr_b16 v[60:61], v213 offset:24576
    v_mfma_f32_32x32x16_bf16 v[36:51], v[108:111], v[100:103], v[36:51]
    ds_read_b64_tr_b16 v[62:63], v213 offset:25088
    ds_read_b128 v[64:67], v11 offset:32768
    ds_read_b64_tr_b16 v[68:69], v212 offset:26624
    ds_read_b64_tr_b16 v[70:71], v212 offset:27136
    v_mfma_f32_32x32x16_bf16 v[20:35], v[116:119], v[112:115], v[20:35]
    ds_read_b64_tr_b16 v[72:73], v213 offset:26624
    ds_read_b64_tr_b16 v[74:75], v213 offset:27136
    ds_read_b128 v[76:79], v12 offset:32768
    ds_read_b64_tr_b16 v[80:81], v212 offset:28672
    v_mfma_f32_32x32x16_bf16 v[36:51], v[120:123], v[112:115], v[36:51]
    ds_read_b64_tr_b16 v[82:83], v212 offset:29184
    ds_read_b64_tr_b16 v[84:85], v213 offset:28672
    ds_read_b64_tr_b16 v[86:87], v213 offset:29184
    ds_read_b128 v[88:91], v13 offset:32768
    v_mfma_f32_32x32x16_bf16 v[20:35], v[128:131], v[124:127], v[20:35]
    ds_read_b64_tr_b16 v[92:93], v212 offset:30720
    ds_read_b64_tr_b16 v[94:95], v212 offset:31232
    ds_read_b64_tr_b16 v[96:97], v213 offset:30720
    ds_read_b64_tr_b16 v[98:99], v213 offset:31232
    v_mfma_f32_32x32x16_bf16 v[36:51], v[132:135], v[124:127], v[36:51]
    v_mfma_f32_32x32x16_bf16 v[20:35], v[140:143], v[136:139], v[20:35]
    v_mfma_f32_32x32x16_bf16 v[36:51], v[144:147], v[136:139], v[36:51]
    s_waitcnt lgkmcnt(0)
    s_barrier
    v_mfma_f32_32x32x16_bf16 v[20:35], v[56:59], v[52:55], v[20:35]
    ds_read_b128 v[100:103], v204 offset:57344
    ds_read_b64_tr_b16 v[104:105], v212 offset:32768
    ds_read_b64_tr_b16 v[106:107], v212 offset:33280
    ds_read_b64_tr_b16 v[108:109], v213 offset:32768
    v_mfma_f32_32x32x16_bf16 v[36:51], v[60:63], v[52:55], v[36:51]
    ds_read_b64_tr_b16 v[110:111], v213 offset:33280
    ds_read_b128 v[112:115], v205 offset:57344
    ds_read_b64_tr_b16 v[116:117], v212 offset:34816
    ds_read_b64_tr_b16 v[118:119], v212 offset:35328
    v_mfma_f32_32x32x16_bf16 v[20:35], v[68:71], v[64:67], v[20:35]
    ds_read_b64_tr_b16 v[120:121], v213 offset:34816
    ds_read_b64_tr_b16 v[122:123], v213 offset:35328
    ds_read_b128 v[124:127], v206 offset:57344
    ds_read_b64_tr_b16 v[128:129], v212 offset:36864
    v_mfma_f32_32x32x16_bf16 v[36:51], v[72:75], v[64:67], v[36:51]
    ds_read_b64_tr_b16 v[130:131], v212 offset:37376
    ds_read_b64_tr_b16 v[132:133], v213 offset:36864
    ds_read_b64_tr_b16 v[134:135], v213 offset:37376
    ds_read_b128 v[136:139], v207 offset:57344
    v_mfma_f32_32x32x16_bf16 v[20:35], v[80:83], v[76:79], v[20:35]
    ds_read_b64_tr_b16 v[140:141], v212 offset:38912
    ds_read_b64_tr_b16 v[142:143], v212 offset:39424
    ds_read_b64_tr_b16 v[144:145], v213 offset:38912
    ds_read_b64_tr_b16 v[146:147], v213 offset:39424
    v_mfma_f32_32x32x16_bf16 v[36:51], v[84:87], v[76:79], v[36:51]
    v_mfma_f32_32x32x16_bf16 v[20:35], v[92:95], v[88:91], v[20:35]
    v_mfma_f32_32x32x16_bf16 v[36:51], v[96:99], v[88:91], v[36:51]
    s_waitcnt lgkmcnt(0)
    s_barrier
    v_mfma_f32_32x32x16_bf16 v[20:35], v[104:107], v[100:103], v[20:35]
    ds_read_b128 v[52:55], v208 offset:8192
    ds_read_b64_tr_b16 v[56:57], v212 offset:40960
    ds_read_b64_tr_b16 v[58:59], v212 offset:41472
    ds_read_b64_tr_b16 v[60:61], v213 offset:40960
    v_mfma_f32_32x32x16_bf16 v[36:51], v[108:111], v[100:103], v[36:51]
    ds_read_b64_tr_b16 v[62:63], v213 offset:41472
    ds_read_b128 v[64:67], v209 offset:8192
    ds_read_b64_tr_b16 v[68:69], v212 offset:43008
    ds_read_b64_tr_b16 v[70:71], v212 offset:43520
    v_mfma_f32_32x32x16_bf16 v[20:35], v[116:119], v[112:115], v[20:35]
    ds_read_b64_tr_b16 v[72:73], v213 offset:43008
    ds_read_b64_tr_b16 v[74:75], v213 offset:43520
    ds_read_b128 v[76:79], v210 offset:8192
    ds_read_b64_tr_b16 v[80:81], v212 offset:45056
    v_mfma_f32_32x32x16_bf16 v[36:51], v[120:123], v[112:115], v[36:51]
    ds_read_b64_tr_b16 v[82:83], v212 offset:45568
    ds_read_b64_tr_b16 v[84:85], v213 offset:45056
    ds_read_b64_tr_b16 v[86:87], v213 offset:45568
    ds_read_b128 v[88:91], v211 offset:8192
    v_mfma_f32_32x32x16_bf16 v[20:35], v[128:131], v[124:127], v[20:35]
    ds_read_b64_tr_b16 v[92:93], v212 offset:47104
    ds_read_b64_tr_b16 v[94:95], v212 offset:47616
    ds_read_b64_tr_b16 v[96:97], v213 offset:47104
    ds_read_b64_tr_b16 v[98:99], v213 offset:47616
    v_mfma_f32_32x32x16_bf16 v[36:51], v[132:135], v[124:127], v[36:51]
    v_mfma_f32_32x32x16_bf16 v[20:35], v[140:143], v[136:139], v[20:35]
    v_mfma_f32_32x32x16_bf16 v[36:51], v[144:147], v[136:139], v[36:51]
    s_waitcnt lgkmcnt(0)
    s_barrier
    v_mfma_f32_32x32x16_bf16 v[20:35], v[56:59], v[52:55], v[20:35]
    ds_read_b128 v[100:103], v10 offset:0
    ds_read_b64_tr_b16 v[104:105], v212 offset:49152
    ds_read_b64_tr_b16 v[106:107], v212 offset:49664
    ds_read_b64_tr_b16 v[108:109], v213 offset:49152
    v_mfma_f32_32x32x16_bf16 v[36:51], v[60:63], v[52:55], v[36:51]
    ds_read_b64_tr_b16 v[110:111], v213 offset:49664
    ds_read_b128 v[112:115], v11 offset:0
    ds_read_b64_tr_b16 v[116:117], v212 offset:51200
    ds_read_b64_tr_b16 v[118:119], v212 offset:51712
    v_mfma_f32_32x32x16_bf16 v[20:35], v[68:71], v[64:67], v[20:35]
    ds_read_b64_tr_b16 v[120:121], v213 offset:51200
    ds_read_b64_tr_b16 v[122:123], v213 offset:51712
    ds_read_b128 v[124:127], v12 offset:0
    ds_read_b64_tr_b16 v[128:129], v212 offset:53248
    v_mfma_f32_32x32x16_bf16 v[36:51], v[72:75], v[64:67], v[36:51]
    ds_read_b64_tr_b16 v[130:131], v212 offset:53760
    ds_read_b64_tr_b16 v[132:133], v213 offset:53248
    ds_read_b64_tr_b16 v[134:135], v213 offset:53760
    ds_read_b128 v[136:139], v13 offset:0
    v_mfma_f32_32x32x16_bf16 v[20:35], v[80:83], v[76:79], v[20:35]
    ds_read_b64_tr_b16 v[140:141], v212 offset:55296
    ds_read_b64_tr_b16 v[142:143], v212 offset:55808
    ds_read_b64_tr_b16 v[144:145], v213 offset:55296
    ds_read_b64_tr_b16 v[146:147], v213 offset:55808
    v_mfma_f32_32x32x16_bf16 v[36:51], v[84:87], v[76:79], v[36:51]
    v_mfma_f32_32x32x16_bf16 v[20:35], v[92:95], v[88:91], v[20:35]
    v_mfma_f32_32x32x16_bf16 v[36:51], v[96:99], v[88:91], v[36:51]
    s_waitcnt lgkmcnt(0)
    s_barrier
    v_mfma_f32_32x32x16_bf16 v[20:35], v[104:107], v[100:103], v[20:35]
    ds_read_b128 v[52:55], v10 offset:16384
    ds_read_b64_tr_b16 v[56:57], v14 offset:53248
    ds_read_b64_tr_b16 v[58:59], v14 offset:53760
    ds_read_b64_tr_b16 v[60:61], v15 offset:53248
    v_mfma_f32_32x32x16_bf16 v[36:51], v[108:111], v[100:103], v[36:51]
    ds_read_b64_tr_b16 v[62:63], v15 offset:53760
    ds_read_b128 v[64:67], v11 offset:16384
    ds_read_b64_tr_b16 v[68:69], v14 offset:55296
    ds_read_b64_tr_b16 v[70:71], v14 offset:55808
    v_mfma_f32_32x32x16_bf16 v[20:35], v[116:119], v[112:115], v[20:35]
    ds_read_b64_tr_b16 v[72:73], v15 offset:55296
    ds_read_b64_tr_b16 v[74:75], v15 offset:55808
    ds_read_b128 v[76:79], v12 offset:16384
    ds_read_b64_tr_b16 v[80:81], v14 offset:57344
    v_mfma_f32_32x32x16_bf16 v[36:51], v[120:123], v[112:115], v[36:51]
    ds_read_b64_tr_b16 v[82:83], v14 offset:57856
    ds_read_b64_tr_b16 v[84:85], v15 offset:57344
    ds_read_b64_tr_b16 v[86:87], v15 offset:57856
    ds_read_b128 v[88:91], v13 offset:16384
    v_mfma_f32_32x32x16_bf16 v[20:35], v[128:131], v[124:127], v[20:35]
    ds_read_b64_tr_b16 v[92:93], v14 offset:59392
    ds_read_b64_tr_b16 v[94:95], v14 offset:59904
    ds_read_b64_tr_b16 v[96:97], v15 offset:59392
    ds_read_b64_tr_b16 v[98:99], v15 offset:59904
    v_mfma_f32_32x32x16_bf16 v[36:51], v[132:135], v[124:127], v[36:51]
    v_mfma_f32_32x32x16_bf16 v[20:35], v[140:143], v[136:139], v[20:35]
    v_mfma_f32_32x32x16_bf16 v[36:51], v[144:147], v[136:139], v[36:51]
    s_waitcnt lgkmcnt(0)
    s_barrier
    v_mfma_f32_32x32x16_bf16 v[20:35], v[56:59], v[52:55], v[20:35]
    ds_read_b128 v[100:103], v10 offset:32768
    ds_read_b64_tr_b16 v[104:105], v212 offset:0
    ds_read_b64_tr_b16 v[106:107], v212 offset:512
    ds_read_b64_tr_b16 v[108:109], v213 offset:0
    v_mfma_f32_32x32x16_bf16 v[36:51], v[60:63], v[52:55], v[36:51]
    ds_read_b64_tr_b16 v[110:111], v213 offset:512
    ds_read_b128 v[112:115], v11 offset:32768
    ds_read_b64_tr_b16 v[116:117], v212 offset:2048
    ds_read_b64_tr_b16 v[118:119], v212 offset:2560
    v_mfma_f32_32x32x16_bf16 v[20:35], v[68:71], v[64:67], v[20:35]
    ds_read_b64_tr_b16 v[120:121], v213 offset:2048
    ds_read_b64_tr_b16 v[122:123], v213 offset:2560
    ds_read_b128 v[124:127], v12 offset:32768
    ds_read_b64_tr_b16 v[128:129], v212 offset:4096
    v_mfma_f32_32x32x16_bf16 v[36:51], v[72:75], v[64:67], v[36:51]
    ds_read_b64_tr_b16 v[130:131], v212 offset:4608
    ds_read_b64_tr_b16 v[132:133], v213 offset:4096
    ds_read_b64_tr_b16 v[134:135], v213 offset:4608
    ds_read_b128 v[136:139], v13 offset:32768
    v_mfma_f32_32x32x16_bf16 v[20:35], v[80:83], v[76:79], v[20:35]
    ds_read_b64_tr_b16 v[140:141], v212 offset:6144
    ds_read_b64_tr_b16 v[142:143], v212 offset:6656
    ds_read_b64_tr_b16 v[144:145], v213 offset:6144
    ds_read_b64_tr_b16 v[146:147], v213 offset:6656
    v_mfma_f32_32x32x16_bf16 v[36:51], v[84:87], v[76:79], v[36:51]
    v_mfma_f32_32x32x16_bf16 v[20:35], v[92:95], v[88:91], v[20:35]
    v_mfma_f32_32x32x16_bf16 v[36:51], v[96:99], v[88:91], v[36:51]
    s_waitcnt lgkmcnt(0)
    s_barrier
    v_mfma_f32_32x32x16_bf16 v[20:35], v[104:107], v[100:103], v[20:35]
    ds_read_b128 v[52:55], v204 offset:57344
    ds_read_b64_tr_b16 v[56:57], v212 offset:8192
    ds_read_b64_tr_b16 v[58:59], v212 offset:8704
    ds_read_b64_tr_b16 v[60:61], v213 offset:8192
    v_mfma_f32_32x32x16_bf16 v[36:51], v[108:111], v[100:103], v[36:51]
    ds_read_b64_tr_b16 v[62:63], v213 offset:8704
    ds_read_b128 v[64:67], v205 offset:57344
    ds_read_b64_tr_b16 v[68:69], v212 offset:10240
    ds_read_b64_tr_b16 v[70:71], v212 offset:10752
    v_mfma_f32_32x32x16_bf16 v[20:35], v[116:119], v[112:115], v[20:35]
    ds_read_b64_tr_b16 v[72:73], v213 offset:10240
    ds_read_b64_tr_b16 v[74:75], v213 offset:10752
    ds_read_b128 v[76:79], v206 offset:57344
    ds_read_b64_tr_b16 v[80:81], v212 offset:12288
    v_mfma_f32_32x32x16_bf16 v[36:51], v[120:123], v[112:115], v[36:51]
    ds_read_b64_tr_b16 v[82:83], v212 offset:12800
    ds_read_b64_tr_b16 v[84:85], v213 offset:12288
    ds_read_b64_tr_b16 v[86:87], v213 offset:12800
    ds_read_b128 v[88:91], v207 offset:57344
    v_mfma_f32_32x32x16_bf16 v[20:35], v[128:131], v[124:127], v[20:35]
    ds_read_b64_tr_b16 v[92:93], v212 offset:14336
    ds_read_b64_tr_b16 v[94:95], v212 offset:14848
    ds_read_b64_tr_b16 v[96:97], v213 offset:14336
    ds_read_b64_tr_b16 v[98:99], v213 offset:14848
    v_mfma_f32_32x32x16_bf16 v[36:51], v[132:135], v[124:127], v[36:51]
    v_mfma_f32_32x32x16_bf16 v[20:35], v[140:143], v[136:139], v[20:35]
    v_mfma_f32_32x32x16_bf16 v[36:51], v[144:147], v[136:139], v[36:51]
    s_waitcnt lgkmcnt(0)
    s_barrier
    v_mfma_f32_32x32x16_bf16 v[20:35], v[56:59], v[52:55], v[20:35]
    ds_read_b128 v[100:103], v208 offset:8192
    ds_read_b64_tr_b16 v[104:105], v212 offset:16384
    ds_read_b64_tr_b16 v[106:107], v212 offset:16896
    ds_read_b64_tr_b16 v[108:109], v213 offset:16384
    v_mfma_f32_32x32x16_bf16 v[36:51], v[60:63], v[52:55], v[36:51]
    ds_read_b64_tr_b16 v[110:111], v213 offset:16896
    ds_read_b128 v[112:115], v209 offset:8192
    ds_read_b64_tr_b16 v[116:117], v212 offset:18432
    ds_read_b64_tr_b16 v[118:119], v212 offset:18944
    v_mfma_f32_32x32x16_bf16 v[20:35], v[68:71], v[64:67], v[20:35]
    ds_read_b64_tr_b16 v[120:121], v213 offset:18432
    ds_read_b64_tr_b16 v[122:123], v213 offset:18944
    ds_read_b128 v[124:127], v210 offset:8192
    ds_read_b64_tr_b16 v[128:129], v212 offset:20480
    v_mfma_f32_32x32x16_bf16 v[36:51], v[72:75], v[64:67], v[36:51]
    ds_read_b64_tr_b16 v[130:131], v212 offset:20992
    ds_read_b64_tr_b16 v[132:133], v213 offset:20480
    ds_read_b64_tr_b16 v[134:135], v213 offset:20992
    ds_read_b128 v[136:139], v211 offset:8192
    v_mfma_f32_32x32x16_bf16 v[20:35], v[80:83], v[76:79], v[20:35]
    ds_read_b64_tr_b16 v[140:141], v212 offset:22528
    ds_read_b64_tr_b16 v[142:143], v212 offset:23040
    ds_read_b64_tr_b16 v[144:145], v213 offset:22528
    ds_read_b64_tr_b16 v[146:147], v213 offset:23040
    v_mfma_f32_32x32x16_bf16 v[36:51], v[84:87], v[76:79], v[36:51]
    v_mfma_f32_32x32x16_bf16 v[20:35], v[92:95], v[88:91], v[20:35]
    v_mfma_f32_32x32x16_bf16 v[36:51], v[96:99], v[88:91], v[36:51]
    s_waitcnt lgkmcnt(0)
    s_barrier
    v_mfma_f32_32x32x16_bf16 v[20:35], v[104:107], v[100:103], v[20:35]
    ds_read_b128 v[52:55], v10 offset:0
    ds_read_b64_tr_b16 v[56:57], v212 offset:24576
    ds_read_b64_tr_b16 v[58:59], v212 offset:25088
    ds_read_b64_tr_b16 v[60:61], v213 offset:24576
    v_mfma_f32_32x32x16_bf16 v[36:51], v[108:111], v[100:103], v[36:51]
    ds_read_b64_tr_b16 v[62:63], v213 offset:25088
    ds_read_b128 v[64:67], v11 offset:0
    ds_read_b64_tr_b16 v[68:69], v212 offset:26624
    ds_read_b64_tr_b16 v[70:71], v212 offset:27136
    v_mfma_f32_32x32x16_bf16 v[20:35], v[116:119], v[112:115], v[20:35]
    ds_read_b64_tr_b16 v[72:73], v213 offset:26624
    ds_read_b64_tr_b16 v[74:75], v213 offset:27136
    ds_read_b128 v[76:79], v12 offset:0
    ds_read_b64_tr_b16 v[80:81], v212 offset:28672
    v_mfma_f32_32x32x16_bf16 v[36:51], v[120:123], v[112:115], v[36:51]
    ds_read_b64_tr_b16 v[82:83], v212 offset:29184
    ds_read_b64_tr_b16 v[84:85], v213 offset:28672
    ds_read_b64_tr_b16 v[86:87], v213 offset:29184
    ds_read_b128 v[88:91], v13 offset:0
    v_mfma_f32_32x32x16_bf16 v[20:35], v[128:131], v[124:127], v[20:35]
    ds_read_b64_tr_b16 v[92:93], v212 offset:30720
    ds_read_b64_tr_b16 v[94:95], v212 offset:31232
    ds_read_b64_tr_b16 v[96:97], v213 offset:30720
    ds_read_b64_tr_b16 v[98:99], v213 offset:31232
    v_mfma_f32_32x32x16_bf16 v[36:51], v[132:135], v[124:127], v[36:51]
    v_mfma_f32_32x32x16_bf16 v[20:35], v[140:143], v[136:139], v[20:35]
    v_mfma_f32_32x32x16_bf16 v[36:51], v[144:147], v[136:139], v[36:51]
    s_waitcnt lgkmcnt(0)
    s_barrier
    v_mfma_f32_32x32x16_bf16 v[20:35], v[56:59], v[52:55], v[20:35]
    ds_read_b128 v[100:103], v10 offset:16384
    ds_read_b64_tr_b16 v[104:105], v212 offset:32768
    ds_read_b64_tr_b16 v[106:107], v212 offset:33280
    ds_read_b64_tr_b16 v[108:109], v213 offset:32768
    v_mfma_f32_32x32x16_bf16 v[36:51], v[60:63], v[52:55], v[36:51]
    ds_read_b64_tr_b16 v[110:111], v213 offset:33280
    ds_read_b128 v[112:115], v11 offset:16384
    ds_read_b64_tr_b16 v[116:117], v212 offset:34816
    ds_read_b64_tr_b16 v[118:119], v212 offset:35328
    v_mfma_f32_32x32x16_bf16 v[20:35], v[68:71], v[64:67], v[20:35]
    ds_read_b64_tr_b16 v[120:121], v213 offset:34816
    ds_read_b64_tr_b16 v[122:123], v213 offset:35328
    ds_read_b128 v[124:127], v12 offset:16384
    ds_read_b64_tr_b16 v[128:129], v212 offset:36864
    v_mfma_f32_32x32x16_bf16 v[36:51], v[72:75], v[64:67], v[36:51]
    ds_read_b64_tr_b16 v[130:131], v212 offset:37376
    ds_read_b64_tr_b16 v[132:133], v213 offset:36864
    ds_read_b64_tr_b16 v[134:135], v213 offset:37376
    ds_read_b128 v[136:139], v13 offset:16384
    v_mfma_f32_32x32x16_bf16 v[20:35], v[80:83], v[76:79], v[20:35]
    ds_read_b64_tr_b16 v[140:141], v212 offset:38912
    ds_read_b64_tr_b16 v[142:143], v212 offset:39424
    ds_read_b64_tr_b16 v[144:145], v213 offset:38912
    ds_read_b64_tr_b16 v[146:147], v213 offset:39424
    v_mfma_f32_32x32x16_bf16 v[36:51], v[84:87], v[76:79], v[36:51]
    v_mfma_f32_32x32x16_bf16 v[20:35], v[92:95], v[88:91], v[20:35]
    v_mfma_f32_32x32x16_bf16 v[36:51], v[96:99], v[88:91], v[36:51]
    s_waitcnt lgkmcnt(0)
    s_barrier
    v_mfma_f32_32x32x16_bf16 v[20:35], v[104:107], v[100:103], v[20:35]
    ds_read_b128 v[52:55], v10 offset:32768
    ds_read_b64_tr_b16 v[56:57], v212 offset:40960
    ds_read_b64_tr_b16 v[58:59], v212 offset:41472
    ds_read_b64_tr_b16 v[60:61], v213 offset:40960
    v_mfma_f32_32x32x16_bf16 v[36:51], v[108:111], v[100:103], v[36:51]
    ds_read_b64_tr_b16 v[62:63], v213 offset:41472
    ds_read_b128 v[64:67], v11 offset:32768
    ds_read_b64_tr_b16 v[68:69], v212 offset:43008
    ds_read_b64_tr_b16 v[70:71], v212 offset:43520
    v_mfma_f32_32x32x16_bf16 v[20:35], v[116:119], v[112:115], v[20:35]
    ds_read_b64_tr_b16 v[72:73], v213 offset:43008
    ds_read_b64_tr_b16 v[74:75], v213 offset:43520
    ds_read_b128 v[76:79], v12 offset:32768
    ds_read_b64_tr_b16 v[80:81], v212 offset:45056
    v_mfma_f32_32x32x16_bf16 v[36:51], v[120:123], v[112:115], v[36:51]
    ds_read_b64_tr_b16 v[82:83], v212 offset:45568
    ds_read_b64_tr_b16 v[84:85], v213 offset:45056
    ds_read_b64_tr_b16 v[86:87], v213 offset:45568
    ds_read_b128 v[88:91], v13 offset:32768
    v_mfma_f32_32x32x16_bf16 v[20:35], v[128:131], v[124:127], v[20:35]
    ds_read_b64_tr_b16 v[92:93], v212 offset:47104
    ds_read_b64_tr_b16 v[94:95], v212 offset:47616
    ds_read_b64_tr_b16 v[96:97], v213 offset:47104
    ds_read_b64_tr_b16 v[98:99], v213 offset:47616
    v_mfma_f32_32x32x16_bf16 v[36:51], v[132:135], v[124:127], v[36:51]
    v_mfma_f32_32x32x16_bf16 v[20:35], v[140:143], v[136:139], v[20:35]
    v_mfma_f32_32x32x16_bf16 v[36:51], v[144:147], v[136:139], v[36:51]
    s_waitcnt lgkmcnt(0)
    s_barrier
    ds_read_b64_tr_b16 v[148:149], v16 offset:0
    ds_read_b64_tr_b16 v[150:151], v16 offset:2048
    ds_read_b64_tr_b16 v[152:153], v16 offset:4096
    ds_read_b64_tr_b16 v[154:155], v16 offset:6144
    ds_read_b64_tr_b16 v[156:157], v16 offset:8192
    ds_read_b64_tr_b16 v[158:159], v16 offset:10240
    ds_read_b64_tr_b16 v[160:161], v16 offset:12288
    ds_read_b64_tr_b16 v[162:163], v16 offset:14336
    v_mfma_f32_32x32x16_bf16 v[20:35], v[56:59], v[52:55], v[20:35]
    ds_read_b128 v[100:103], v204 offset:57344
    ds_read_b64_tr_b16 v[104:105], v212 offset:49152
    ds_read_b64_tr_b16 v[106:107], v212 offset:49664
    ds_read_b64_tr_b16 v[108:109], v213 offset:49152
    v_mfma_f32_32x32x16_bf16 v[36:51], v[60:63], v[52:55], v[36:51]
    ds_read_b64_tr_b16 v[110:111], v213 offset:49664
    ds_read_b128 v[112:115], v205 offset:57344
    ds_read_b64_tr_b16 v[116:117], v212 offset:51200
    ds_read_b64_tr_b16 v[118:119], v212 offset:51712
    v_mfma_f32_32x32x16_bf16 v[20:35], v[68:71], v[64:67], v[20:35]
    ds_read_b64_tr_b16 v[120:121], v213 offset:51200
    ds_read_b64_tr_b16 v[122:123], v213 offset:51712
    ds_read_b128 v[124:127], v206 offset:57344
    ds_read_b64_tr_b16 v[128:129], v212 offset:53248
    v_mfma_f32_32x32x16_bf16 v[36:51], v[72:75], v[64:67], v[36:51]
    ds_read_b64_tr_b16 v[130:131], v212 offset:53760
    ds_read_b64_tr_b16 v[132:133], v213 offset:53248
    ds_read_b64_tr_b16 v[134:135], v213 offset:53760
    ds_read_b128 v[136:139], v207 offset:57344
    v_mfma_f32_32x32x16_bf16 v[20:35], v[80:83], v[76:79], v[20:35]
    ds_read_b64_tr_b16 v[140:141], v212 offset:55296
    ds_read_b64_tr_b16 v[142:143], v212 offset:55808
    ds_read_b64_tr_b16 v[144:145], v213 offset:55296
    ds_read_b64_tr_b16 v[146:147], v213 offset:55808
    v_mfma_f32_32x32x16_bf16 v[36:51], v[84:87], v[76:79], v[36:51]
    v_mfma_f32_32x32x16_bf16 v[20:35], v[92:95], v[88:91], v[20:35]
    v_mfma_f32_32x32x16_bf16 v[36:51], v[96:99], v[88:91], v[36:51]
    s_waitcnt lgkmcnt(0)
    s_waitcnt vmcnt(0)
    v_mfma_f32_32x32x16_bf16 v[20:35], v[104:107], v[100:103], v[20:35]
    v_lshlrev_b32 v196, 16, v216
    v_lshlrev_b32 v197, 16, v148
    v_mul_f32 v196, v196, v197
    v_mul_f32 v164, v196, v238
    v_and_b32 v196, 0xffff0000, v216
    v_and_b32 v197, 0xffff0000, v148
    v_mul_f32 v196, v196, v197
    v_mul_f32 v165, v196, v238
    v_lshlrev_b32 v196, 16, v217
    v_lshlrev_b32 v197, 16, v149
    v_mul_f32 v196, v196, v197
    v_mul_f32 v166, v196, v238
    v_and_b32 v196, 0xffff0000, v217
    v_and_b32 v197, 0xffff0000, v149
    v_mul_f32 v196, v196, v197
    v_mul_f32 v167, v196, v238
    v_mfma_f32_32x32x16_bf16 v[36:51], v[108:111], v[100:103], v[36:51]
    v_lshlrev_b32 v196, 16, v218
    v_lshlrev_b32 v197, 16, v150
    v_mul_f32 v196, v196, v197
    v_mul_f32 v168, v196, v238
    v_and_b32 v196, 0xffff0000, v218
    v_and_b32 v197, 0xffff0000, v150
    v_mul_f32 v196, v196, v197
    v_mul_f32 v169, v196, v238
    v_lshlrev_b32 v196, 16, v219
    v_lshlrev_b32 v197, 16, v151
    v_mul_f32 v196, v196, v197
    v_mul_f32 v170, v196, v238
    v_and_b32 v196, 0xffff0000, v219
    v_and_b32 v197, 0xffff0000, v151
    v_mul_f32 v196, v196, v197
    v_mul_f32 v171, v196, v238
    v_mfma_f32_32x32x16_bf16 v[20:35], v[116:119], v[112:115], v[20:35]
    v_lshlrev_b32 v196, 16, v220
    v_lshlrev_b32 v197, 16, v152
    v_mul_f32 v196, v196, v197
    v_mul_f32 v172, v196, v238
    v_and_b32 v196, 0xffff0000, v220
    v_and_b32 v197, 0xffff0000, v152
    v_mul_f32 v196, v196, v197
    v_mul_f32 v173, v196, v238
    v_lshlrev_b32 v196, 16, v221
    v_lshlrev_b32 v197, 16, v153
    v_mul_f32 v196, v196, v197
    v_mul_f32 v174, v196, v238
    v_and_b32 v196, 0xffff0000, v221
    v_and_b32 v197, 0xffff0000, v153
    v_mul_f32 v196, v196, v197
    v_mul_f32 v175, v196, v238
    v_mfma_f32_32x32x16_bf16 v[36:51], v[120:123], v[112:115], v[36:51]
    v_lshlrev_b32 v196, 16, v222
    v_lshlrev_b32 v197, 16, v154
    v_mul_f32 v196, v196, v197
    v_mul_f32 v176, v196, v238
    v_and_b32 v196, 0xffff0000, v222
    v_and_b32 v197, 0xffff0000, v154
    v_mul_f32 v196, v196, v197
    v_mul_f32 v177, v196, v238
    v_lshlrev_b32 v196, 16, v223
    v_lshlrev_b32 v197, 16, v155
    v_mul_f32 v196, v196, v197
    v_mul_f32 v178, v196, v238
    v_and_b32 v196, 0xffff0000, v223
    v_and_b32 v197, 0xffff0000, v155
    v_mul_f32 v196, v196, v197
    v_mul_f32 v179, v196, v238
    v_mfma_f32_32x32x16_bf16 v[20:35], v[128:131], v[124:127], v[20:35]
    v_lshlrev_b32 v196, 16, v224
    v_lshlrev_b32 v197, 16, v156
    v_mul_f32 v196, v196, v197
    v_mul_f32 v180, v196, v238
    v_and_b32 v196, 0xffff0000, v224
    v_and_b32 v197, 0xffff0000, v156
    v_mul_f32 v196, v196, v197
    v_mul_f32 v181, v196, v238
    v_lshlrev_b32 v196, 16, v225
    v_lshlrev_b32 v197, 16, v157
    v_mul_f32 v196, v196, v197
    v_mul_f32 v182, v196, v238
    v_and_b32 v196, 0xffff0000, v225
    v_and_b32 v197, 0xffff0000, v157
    v_mul_f32 v196, v196, v197
    v_mul_f32 v183, v196, v238
    v_mfma_f32_32x32x16_bf16 v[36:51], v[132:135], v[124:127], v[36:51]
    v_lshlrev_b32 v196, 16, v226
    v_lshlrev_b32 v197, 16, v158
    v_mul_f32 v196, v196, v197
    v_mul_f32 v184, v196, v238
    v_and_b32 v196, 0xffff0000, v226
    v_and_b32 v197, 0xffff0000, v158
    v_mul_f32 v196, v196, v197
    v_mul_f32 v185, v196, v238
    v_lshlrev_b32 v196, 16, v227
    v_lshlrev_b32 v197, 16, v159
    v_mul_f32 v196, v196, v197
    v_mul_f32 v186, v196, v238
    v_and_b32 v196, 0xffff0000, v227
    v_and_b32 v197, 0xffff0000, v159
    v_mul_f32 v196, v196, v197
    v_mul_f32 v187, v196, v238
    v_mfma_f32_32x32x16_bf16 v[20:35], v[140:143], v[136:139], v[20:35]
    v_lshlrev_b32 v196, 16, v228
    v_lshlrev_b32 v197, 16, v160
    v_mul_f32 v196, v196, v197
    v_mul_f32 v188, v196, v238
    v_and_b32 v196, 0xffff0000, v228
    v_and_b32 v197, 0xffff0000, v160
    v_mul_f32 v196, v196, v197
    v_mul_f32 v189, v196, v238
    v_lshlrev_b32 v196, 16, v229
    v_lshlrev_b32 v197, 16, v161
    v_mul_f32 v196, v196, v197
    v_mul_f32 v190, v196, v238
    v_and_b32 v196, 0xffff0000, v229
    v_and_b32 v197, 0xffff0000, v161
    v_mul_f32 v196, v196, v197
    v_mul_f32 v191, v196, v238
    v_mfma_f32_32x32x16_bf16 v[36:51], v[144:147], v[136:139], v[36:51]
    v_lshlrev_b32 v196, 16, v230
    v_lshlrev_b32 v197, 16, v162
    v_mul_f32 v196, v196, v197
    v_mul_f32 v192, v196, v238
    v_and_b32 v196, 0xffff0000, v230
    v_and_b32 v197, 0xffff0000, v162
    v_mul_f32 v196, v196, v197
    v_mul_f32 v193, v196, v238
    v_lshlrev_b32 v196, 16, v231
    v_lshlrev_b32 v197, 16, v163
    v_mul_f32 v196, v196, v197
    v_mul_f32 v194, v196, v238
    v_and_b32 v196, 0xffff0000, v231
    v_and_b32 v197, 0xffff0000, v163
    v_mul_f32 v196, v196, v197
    v_mul_f32 v195, v196, v238
    s_nop 7
    s_nop 3
    v_fma_f32 v20, v20, v239, v164
    v_fma_f32 v21, v21, v239, v165
    v_fma_f32 v22, v22, v239, v166
    v_fma_f32 v23, v23, v239, v167
    v_fma_f32 v24, v24, v239, v168
    v_fma_f32 v25, v25, v239, v169
    v_fma_f32 v26, v26, v239, v170
    v_fma_f32 v27, v27, v239, v171
    v_fma_f32 v28, v28, v239, v172
    v_fma_f32 v29, v29, v239, v173
    v_fma_f32 v30, v30, v239, v174
    v_fma_f32 v31, v31, v239, v175
    v_fma_f32 v32, v32, v239, v176
    v_fma_f32 v33, v33, v239, v177
    v_fma_f32 v34, v34, v239, v178
    v_fma_f32 v35, v35, v239, v179
    v_cvt_pk_bf16_f32 v52, v20, v21
    v_cvt_pk_bf16_f32 v53, v22, v23
    v_cvt_pk_bf16_f32 v54, v24, v25
    v_cvt_pk_bf16_f32 v55, v26, v27
    v_cvt_pk_bf16_f32 v56, v28, v29
    v_cvt_pk_bf16_f32 v57, v30, v31
    v_cvt_pk_bf16_f32 v58, v32, v33
    v_cvt_pk_bf16_f32 v59, v34, v35
    s_nop 1
    v_permlane32_swap_b32 v52, v54
    v_permlane32_swap_b32 v53, v55
    v_permlane32_swap_b32 v56, v58
    v_permlane32_swap_b32 v57, v59
    buffer_store_dwordx4 v[52:55], v17, s[56:59], 0 offen offset:0
    buffer_store_dwordx4 v[56:59], v17, s[56:59], 0 offen offset:32
    v_fma_f32 v36, v36, v239, v180
    v_fma_f32 v37, v37, v239, v181
    v_fma_f32 v38, v38, v239, v182
    v_fma_f32 v39, v39, v239, v183
    v_fma_f32 v40, v40, v239, v184
    v_fma_f32 v41, v41, v239, v185
    v_fma_f32 v42, v42, v239, v186
    v_fma_f32 v43, v43, v239, v187
    v_fma_f32 v44, v44, v239, v188
    v_fma_f32 v45, v45, v239, v189
    v_fma_f32 v46, v46, v239, v190
    v_fma_f32 v47, v47, v239, v191
    v_fma_f32 v48, v48, v239, v192
    v_fma_f32 v49, v49, v239, v193
    v_fma_f32 v50, v50, v239, v194
    v_fma_f32 v51, v51, v239, v195
    v_cvt_pk_bf16_f32 v60, v36, v37
    v_cvt_pk_bf16_f32 v61, v38, v39
    v_cvt_pk_bf16_f32 v62, v40, v41
    v_cvt_pk_bf16_f32 v63, v42, v43
    v_cvt_pk_bf16_f32 v64, v44, v45
    v_cvt_pk_bf16_f32 v65, v46, v47
    v_cvt_pk_bf16_f32 v66, v48, v49
    v_cvt_pk_bf16_f32 v67, v50, v51
    s_nop 1
    v_permlane32_swap_b32 v60, v62
    v_permlane32_swap_b32 v61, v63
    v_permlane32_swap_b32 v64, v66
    v_permlane32_swap_b32 v65, v67
    buffer_store_dwordx4 v[60:63], v17, s[56:59], 0 offen offset:64
    buffer_store_dwordx4 v[64:67], v17, s[56:59], 0 offen offset:96
MK_FIN:
MK_END:
    s_endpgm

.section .rodata,"a"
.p2align 6
.amdhsa_kernel gated_mix__ssm_conv_h3__grouped_kv_mqa__prompt_kernel
  .amdhsa_next_free_vgpr 256
  .amdhsa_next_free_sgpr 102
  .amdhsa_accum_offset 256
  .amdhsa_group_segment_fixed_size 0
  .amdhsa_kernarg_size 120
  .amdhsa_user_sgpr_count 2
  .amdhsa_user_sgpr_kernarg_segment_ptr 1
  .amdhsa_system_sgpr_workgroup_id_x 1
  .amdhsa_float_denorm_mode_32 3
  .amdhsa_float_denorm_mode_16_64 3
.end_amdhsa_kernel
```
